```python
import torch

def _softmax(x, axis=-1):
    return torch.softmax(x, dim=axis)
def _gelu(x):
    return torch.nn.functional.gelu(x, approximate="tanh")
def _silu(x):
    return torch.nn.functional.silu(x)
def _sigmoid(x):
    return torch.sigmoid(x)
def _layernorm(x, axis=-1, eps=1e-5):
    m = x.mean(dim=axis, keepdim=True)
    v = x.var(dim=axis, keepdim=True, unbiased=False)
    return (x - m) / torch.sqrt(v + eps)
def _scatter_add(tgt, idx, src, axis=0):
    return tgt.clone().index_add_(axis, idx, src)
def _segment_sum(src, seg, n):
    out = torch.zeros((n,) + src.shape[1:], dtype=src.dtype)
    return out.index_add_(0, seg, src)
def _pad(x, pw):
    flat = tuple(v for pair in reversed(pw) for v in pair)
    return torch.nn.functional.pad(x, flat)

kernel_name = 'gated_mix__ssm_conv_s5__mixer_channel_mlp__prompt'

def setup_inputs():

    _w = (lambda a: (lambda t: t.to(torch.bfloat16) if t.is_floating_point() else t)(torch.as_tensor(a)))
    def _A_setup():
        B, S, D = 1, 2048, 512
        P = D
        Lambda_re = -0.5 * (lambda _x: torch.exp(torch.as_tensor(_x)))((lambda *s: torch.randn(*s, dtype=torch.bfloat16) * 0.4)(P))
        Lambda_im = (lambda *s: torch.randn(*s, dtype=torch.bfloat16) * 0.8)(P) * 1.0
        B_re = (lambda *s: torch.randn(*s, dtype=torch.bfloat16) * 0.8)(P, D) * (D ** -0.5)
        B_im = (lambda *s: torch.randn(*s, dtype=torch.bfloat16) * 0.8)(P, D) * (D ** -0.5)
        C_re = (lambda *s: torch.randn(*s, dtype=torch.bfloat16) * 0.8)(D, P) * (P ** -0.5)
        C_im = (lambda *s: torch.randn(*s, dtype=torch.bfloat16) * 0.8)(D, P) * (P ** -0.5)
        log_dt = (lambda *s: torch.randn(*s, dtype=torch.bfloat16) * 0.4)(P) * 0.3 - 2.0
        Dskip = (lambda *s: torch.randn(*s, dtype=torch.bfloat16) * 0.1)(D)
        return {
            "x": _w((lambda *s: torch.randn(*s, dtype=torch.bfloat16) * 0.05)(B, S, D)),
            "Lambda_re": _w(Lambda_re),
            "Lambda_im": _w(Lambda_im),
            "B_re": _w(B_re),
            "B_im": _w(B_im),
            "C_re": _w(C_re),
            "C_im": _w(C_im),
            "log_dt": _w(log_dt),
            "Dskip": _w(Dskip),
        }
    _A_in = _A_setup()

    def _B_setup():
        B, S, D, F = 1, 2048, 512, 1376
        return {
            "x": _w((lambda *s: torch.randn(*s, dtype=torch.bfloat16) * 0.05)(B, S, D)),
            "w1": _w((lambda *s: torch.randn(*s, dtype=torch.bfloat16) * 0.8)(D, F) * (D ** -0.5)),
            "b1": _w((lambda *s: torch.randn(*s, dtype=torch.bfloat16) * 0.4)(F)),
            "w2": _w((lambda *s: torch.randn(*s, dtype=torch.bfloat16) * 0.05)(F, D) * (F ** -0.5)),
            "b2": _w((lambda *s: torch.randn(*s, dtype=torch.bfloat16) * 0.05)(D)),
        }
    _B_in = _B_setup()

    return {
        "A_x": _A_in["x"],
        "A_Lambda_re": _A_in["Lambda_re"],
        "A_Lambda_im": _A_in["Lambda_im"],
        "A_B_re": _A_in["B_re"],
        "A_B_im": _A_in["B_im"],
        "A_C_re": _A_in["C_re"],
        "A_C_im": _A_in["C_im"],
        "A_log_dt": _A_in["log_dt"],
        "A_Dskip": _A_in["Dskip"],
        "B_x": _B_in["x"],
        "B_w1": _B_in["w1"],
        "B_b1": _B_in["b1"],
        "B_w2": _B_in["w2"],
        "B_b2": _B_in["b2"],
        "gate_w": _w((lambda *s: torch.randn(*s, dtype=torch.bfloat16) * 0.05)(512) * 16.0),
    }

def reference(A_x, A_Lambda_re, A_Lambda_im, A_B_re, A_B_im, A_C_re, A_C_im, A_log_dt, A_Dskip, B_x, B_w1, B_b1, B_w2, B_b2, gate_w):
    def _A_ref(x, Lambda_re, Lambda_im, B_re, B_im, C_re, C_im, log_dt, Dskip):
        Bsz, L, H = x.shape
        Lam = Lambda_re + 1j * Lambda_im
        Bmat = B_re + 1j * B_im
        Cmat = C_re + 1j * C_im
        dt = torch.exp(log_dt)
        Lam_bar = torch.exp(dt * Lam)
        B_bar = ((Lam_bar - 1.0) / Lam)[:, None] * Bmat
        Bu = torch.einsum("bld,pd->blp", x + 0j, B_bar)
        h = torch.zeros_like(Bu[:, 0, :])
        hs = []
        for t in range(L):
            h = Lam_bar[None, :] * h + Bu[:, t, :]
            hs.append(h)
        hseq = torch.stack(hs, 1)
        y = 2.0 * torch.einsum("blp,dp->bld", hseq, Cmat).real + x * Dskip[None, None, :]
        return y

    def _B_ref(x, w1, b1, w2, b2):
        y = _layernorm(x, axis=-1)
        h = _gelu(torch.einsum("bsd,df->bsf", y, w1) + b1)
        return torch.einsum("bsf,fd->bsd", h, w2) + b2

    x = A_x
    g = _sigmoid((x * gate_w).sum(-1, keepdims=True))
    a = _A_ref(x, A_Lambda_re, A_Lambda_im, A_B_re, A_B_im, A_C_re, A_C_im, A_log_dt, A_Dskip)
    b = _B_ref(x, B_w1, B_b1, B_w2, B_b2)
    return g * a + (1 - g) * b
```

```asm
; @launch grid=(256,1,1) block=(512,1,1) lds=163840
.amdgcn_target "amdgcn-amd-amdhsa--gfx950"
.text
.globl gated_mix__ssm_conv_s5__mixer_channel_mlp__prompt_kernel
.p2align 8
.type gated_mix__ssm_conv_s5__mixer_channel_mlp__prompt_kernel,@function
gated_mix__ssm_conv_s5__mixer_channel_mlp__prompt_kernel:
    s_cmp_ge_u32 s2, 256
    s_cbranch_scc1 L_end
    s_load_dwordx16 s[16:31], s[0:1], 0
    s_load_dwordx16 s[32:47], s[0:1], 64
    s_load_dwordx4 s[48:51], s[0:1], 128
    v_lshrrev_b32 v6, 6, v0
    v_and_b32 v1, 63, v0
    v_readfirstlane_b32 s7, v6
    s_and_b32 s10, s2, 7
    s_lshr_b32 s11, s2, 3
    s_lshr_b32 s12, s10, 1
    s_lshl_b32 s12, s12, 2
    s_lshr_b32 s13, s11, 3
    s_add_u32 s4, s12, s13
    s_and_b32 s12, s10, 1
    s_lshl_b32 s12, s12, 3
    s_and_b32 s11, s11, 7
    s_add_u32 s5, s12, s11
    s_and_b32 s12, s10, 6
    s_and_b32 s95, s10, 1
    s_lshl_b32 s95, s95, 2
    s_add_u32 s95, s95, s12
    s_add_u32 s12, s11, s13
    s_and_b32 s12, s12, 3
    s_add_u32 s95, s95, s12
    s_min_u32 s10, s5, 11
    s_lshl_b32 s10, s10, 1
    s_lshl_b32 s11, s5, 2
    s_add_u32 s6, s10, s11
    v_and_b32 v2, 31, v1
    v_lshrrev_b32 v3, 5, v1
    v_lshlrev_b32 v4, 4, v1
    s_and_b32 s3, s7, 3
    s_lshl_b32 s10, s3, 12
    s_add_u32 s91, s10, 24576
    s_lshl_b32 s92, s3, 11
    v_and_b32 v6, 255, v0
    v_lshlrev_b32 v6, 3, v6
    v_mov_b32 v8, 0
    v_mov_b32 v9, 0
    ds_write_b64 v6, v[8:9] offset:9472
    v_mov_b32 v0, 0
    s_cmp_ge_u32 s7, 4
    s_cbranch_scc1 L_roleB
    s_setprio 1
    v_lshrrev_b32 v6, 1, v2
    v_and_b32 v6, 7, v6
    v_xor_b32 v6, v6, v3
    v_lshlrev_b32 v6, 4, v6
    v_lshl_add_u32 v68, v2, 7, v6
    v_xor_b32 v69, 32, v68
    v_xor_b32 v70, 64, v68
    v_xor_b32 v71, 96, v68
    v_add_u32 v72, s91, v68
    v_add_u32 v73, s91, v69
    v_add_u32 v74, s91, v70
    v_add_u32 v75, s91, v71
    v_add_u32 v68, 16384, v68
    v_add_u32 v69, 16384, v69
    v_add_u32 v70, 16384, v70
    v_add_u32 v71, 16384, v71
    s_lshl_b32 s10, s5, 6
    v_lshl_add_u32 v13, v2, 1, s10
    v_lshlrev_b32_e64 v12, 1, v2
    s_lshl_b32 s10, s4, 2
    s_add_u32 s10, s10, s3
    s_mul_i32 s94, s10, 153600
    s_lshl_b32 s96, s6, 5
    v_bfe_u32 v6, v1, 2, 2
    v_lshl_add_u32 v6, v3, 3, v6
    v_bfe_u32 v7, v1, 4, 1
    v_and_b32 v8, 3, v1
    v_lshlrev_b32 v8, 3, v8
    v_lshl_add_u32 v7, v7, 5, v8
    v_lshl_add_u32 v6, v6, 6, v7
    v_add_u32 v14, 65536, v6
    v_add_u32 v15, 131072, v6
    v_lshrrev_b32_e64 v6, 2, v1
    v_mul_u32_u24 v6, 2752, v6
    v_and_b32 v7, 3, v1
    v_lshl_add_u32 v120, v7, 4, v6
    v_add_u32 v121, 43008, v120
    s_waitcnt lgkmcnt(0)
    s_mov_b32 s98, 0
    s_lshl_b32 s10, s4, 7
    s_add_u32 s10, s10, 0xb00000
    s_load_dword s8, s[50:51], s10
    s_lshl_b32 s11, s5, 7
    s_add_u32 s11, s11, 0xb00800
    s_load_dword s9, s[50:51], s11
    s_mov_b32 s52, s16
    s_and_b32 s53, s17, 0xffff
    s_mov_b32 s54, 0x200000
    s_mov_b32 s55, 0x20000
    s_mov_b32 s60, s36
    s_and_b32 s61, s37, 0xffff
    s_mov_b32 s62, 0x158000
    s_mov_b32 s63, 0x20000
    s_lshl_b32 s10, s4, 7
    s_lshl_b32 s11, s5, 3
    s_add_u32 s10, s10, s11
    s_lshl_b32 s11, s3, 1
    s_add_u32 s7, s10, s11
    s_lshl_b32 s10, s7, 10
    buffer_load_dwordx4 v[36:39], v4, s[52:55], s10 offen
    buffer_load_dwordx4 v[40:43], v4, s[52:55], s10 offen offset:1024
    global_load_dwordx4 v[44:47], v4, s[44:45]
    s_mov_b32 s68, s38
    s_and_b32 s69, s39, 0xffff
    s_mov_b32 s70, 0xac0
    s_mov_b32 s71, 0x20000
    s_mov_b32 s64, s50
    s_and_b32 s65, s51, 0xffff
    s_mov_b32 s66, 0xc00000
    s_mov_b32 s67, 0x20000
    s_add_u32 s10, s6, 64
    s_lshl_b32 s10, s10, 10
    s_add_u32 s99, s10, s94
    s_lshl_b32 s10, s5, 12
    s_add_u32 s100, s10, s94
    s_lshl_b32 s10, s4, 6
    s_add_u32 s10, s10, s5
    s_lshl_b32 s10, s10, 2
    s_add_u32 s10, s10, s3
    s_lshl_b32 s10, s10, 7
    s_add_u32 s101, s10, 0xa80000
    s_mul_i32 s10, s4, 88064
    s_lshl_b32 s11, s6, 5
    s_add_u32 s10, s10, s11
    s_mov_b32 m0, s92
    s_lshl_b32 s12, s3, 6
    s_add_u32 s10, s10, s12
    buffer_load_dwordx4 v120, s[60:63], s10 offen  lds
    buffer_load_dwordx4 v121, s[60:63], s10 offen offset:1024  lds
    global_load_ushort v124, v13, s[18:19]
    global_load_ushort v125, v13, s[20:21]
    global_load_ushort v126, v13, s[30:31]
    buffer_load_ushort v28, v12, s[68:71], s96 offen offset:0
    buffer_load_ushort v29, v12, s[68:71], s96 offen offset:64
    buffer_load_ushort v30, v12, s[68:71], s96 offen offset:128
    s_waitcnt vmcnt(8) lgkmcnt(0)
    v_mov_b32 v52, 0
    v_mov_b32 v53, 0
    v_mov_b32 v54, 0
    v_mov_b32 v55, 0
    v_mov_b32 v56, 0
    v_mov_b32_e64 v57, 0
    v_mov_b32 v89, 0x3f803f80
    v_mov_b32_e64 v90, 0
    s_add_u32 s8, s8, 0x9e3779b9
    s_add_u32 s9, s9, 0x9e3779b9
    v_dot2c_f32_bf16 v52, v36, v89
    v_dot2c_f32_bf16 v54, v36, v36
    v_dot2c_f32_bf16 v53, v40, v89
    v_dot2c_f32_bf16 v55, v40, v40
    v_dot2c_f32_bf16 v52, v37, v89
    v_dot2c_f32_bf16 v54, v37, v37
    v_dot2c_f32_bf16 v53, v41, v89
    v_dot2c_f32_bf16 v55, v41, v41
    v_dot2c_f32_bf16 v52, v38, v89
    v_dot2c_f32_bf16 v54, v38, v38
    v_dot2c_f32_bf16 v53, v42, v89
    v_dot2c_f32_bf16 v55, v42, v42
    v_dot2c_f32_bf16 v52, v39, v89
    v_dot2c_f32_bf16 v54, v39, v39
    v_dot2c_f32_bf16 v53, v43, v89
    v_dot2c_f32_bf16 v55, v43, v43
    v_lshlrev_b32_e64 v96, 16, v44
    v_and_b32 v97, 0xffff0000, v44
    v_lshlrev_b32_e64 v98, 16, v45
    v_and_b32 v99, 0xffff0000, v45
    v_lshlrev_b32_e64 v100, 16, v46
    v_and_b32 v101, 0xffff0000, v46
    v_lshlrev_b32_e64 v102, 16, v47
    v_and_b32 v103, 0xffff0000, v47
    v_lshlrev_b32_e64 v104, 16, v36
    v_and_b32 v105, 0xffff0000, v36
    v_lshlrev_b32_e64 v106, 16, v37
    v_and_b32 v107, 0xffff0000, v37
    v_lshlrev_b32_e64 v108, 16, v38
    v_and_b32 v109, 0xffff0000, v38
    v_lshlrev_b32_e64 v110, 16, v39
    v_and_b32 v111, 0xffff0000, v39
    v_pk_mul_f32 v[104:105], v[104:105], v[96:97]
    v_pk_mul_f32 v[106:107], v[106:107], v[98:99]
    v_pk_mul_f32 v[108:109], v[108:109], v[100:101]
    v_pk_mul_f32 v[110:111], v[110:111], v[102:103]
    v_cvt_pk_bf16_f32 v36, v104, v105
    v_cvt_pk_bf16_f32 v37, v106, v107
    v_cvt_pk_bf16_f32 v38, v108, v109
    v_cvt_pk_bf16_f32 v39, v110, v111
    v_dot2c_f32_bf16 v56, v36, v89
    v_dot2c_f32_bf16 v56, v37, v89
    v_dot2c_f32_bf16 v56, v38, v89
    v_dot2c_f32_bf16 v56, v39, v89
    v_lshlrev_b32_e64 v104, 16, v40
    v_and_b32 v105, 0xffff0000, v40
    v_lshlrev_b32_e64 v106, 16, v41
    v_and_b32 v107, 0xffff0000, v41
    v_lshlrev_b32_e64 v108, 16, v42
    v_and_b32 v109, 0xffff0000, v42
    v_lshlrev_b32_e64 v110, 16, v43
    v_and_b32 v111, 0xffff0000, v43
    v_pk_mul_f32 v[104:105], v[104:105], v[96:97]
    v_pk_mul_f32 v[106:107], v[106:107], v[98:99]
    v_pk_mul_f32 v[108:109], v[108:109], v[100:101]
    v_pk_mul_f32 v[110:111], v[110:111], v[102:103]
    v_cvt_pk_bf16_f32 v40, v104, v105
    v_cvt_pk_bf16_f32 v41, v106, v107
    v_cvt_pk_bf16_f32 v42, v108, v109
    v_cvt_pk_bf16_f32 v43, v110, v111
    v_dot2c_f32_bf16 v57, v40, v89
    v_dot2c_f32_bf16 v57, v41, v89
    v_dot2c_f32_bf16 v57, v42, v89
    v_dot2c_f32_bf16 v57, v43, v89
    v_permlane32_swap_b32 v52, v53
    v_permlane32_swap_b32 v54, v55
    s_nop 0
    v_permlane32_swap_b32 v56, v57
    v_add_f32 v52, v52, v53
    v_add_f32 v54, v54, v55
    v_add_f32_e64 v56, v56, v57
    v_add_f32_dpp v52, v52, v52 row_shr:1 row_mask:0xf bank_mask:0xf
    v_add_f32_dpp v54, v54, v54 row_shr:1 row_mask:0xf bank_mask:0xf
    v_add_f32_dpp v56, v56, v56 row_shr:1 row_mask:0xf bank_mask:0xf
    v_add_f32_dpp v52, v52, v52 row_shr:2 row_mask:0xf bank_mask:0xf
    v_add_f32_dpp v54, v54, v54 row_shr:2 row_mask:0xf bank_mask:0xf
    v_add_f32_dpp v56, v56, v56 row_shr:2 row_mask:0xf bank_mask:0xf
    v_add_f32_dpp v52, v52, v52 row_shr:4 row_mask:0xf bank_mask:0xf
    v_add_f32_dpp v54, v54, v54 row_shr:4 row_mask:0xf bank_mask:0xf
    v_add_f32_dpp v56, v56, v56 row_shr:4 row_mask:0xf bank_mask:0xf
    v_add_f32_dpp v52, v52, v52 row_shr:8 row_mask:0xf bank_mask:0xf
    v_add_f32_dpp v54, v54, v54 row_shr:8 row_mask:0xf bank_mask:0xf
    v_add_f32_dpp v56, v56, v56 row_shr:8 row_mask:0xf bank_mask:0xf
    v_add_f32_dpp v52, v52, v52 row_bcast:15 row_mask:0xa bank_mask:0xf
    v_add_f32_dpp v54, v54, v54 row_bcast:15 row_mask:0xa bank_mask:0xf
    v_add_f32_dpp v56, v56, v56 row_bcast:15 row_mask:0xa bank_mask:0xf
    v_mul_f32 v52, 0x3b000000, v52
    v_mul_f32 v54, 0x3b000000, v54
    v_fma_f32 v54, -v52, v52, v54
    v_max_f32_e64 v54, 0, v54
    v_cvt_pk_bf16_f32 v53, v54, v56
    v_lshlrev_b32_e64 v54, 16, v53
    v_and_b32 v56, 0xffff0000, v53
    v_add_f32 v54, 0x3727c5ac, v54
    v_mul_f32 v56, 0xbfb8aa3b, v56
    v_cvt_pk_bf16_f32 v54, v54, v54
    v_exp_f32 v56, v56
    v_lshlrev_b32 v54, 16, v54
    v_add_f32 v56, 1.0, v56
    v_sqrt_f32 v54, v54
    v_rcp_f32 v56, v56
    v_mov_b32 v53, s8
    v_mov_b32_e64 v55, s8
    v_cvt_pk_bf16_f32 v52, v52, v54
    v_cvt_pk_bf16_f32 v56, v56, v56
    v_lshlrev_b32 v56, 16, v56
    v_sub_f32 v57, 1.0, v56
    v_cvt_pk_bf16_f32 v54, v56, v57
    s_lshl_b32 s10, s7, 4
    s_add_u32 s10, s10, 0xa00000
    v_lshlrev_b32 v92, 4, v3
    s_mov_b32 exec_lo, 0x80000000
    s_mov_b32 exec_hi, 0x80000000
    buffer_store_dwordx4 v[52:55], v92, s[64:67], s10 offen sc1
    s_mov_b64 exec, -1
    v_bfe_u32 v76, v1, 2, 2
    v_lshl_add_u32 v76, v3, 3, v76
    v_bfe_u32 v77, v1, 4, 1
    v_and_b32 v78, 3, v1
    v_lshlrev_b32_e64 v78, 3, v78
    v_lshl_add_u32 v77, v77, 5, v78
    v_lshl_add_u32 v76, v76, 6, v77
    v_add_u32_e64 v76, s92, v76
    v_mov_b32 v77, 0x3f803f80
    v_mov_b32 v78, 0
    s_waitcnt vmcnt(7)
    ds_read_b64_tr_b16 v[80:81], v76 offset:0
    ds_read_b64_tr_b16 v[82:83], v76 offset:256
    ds_read_b64_tr_b16 v[84:85], v76 offset:1024
    ds_read_b64_tr_b16 v[86:87], v76 offset:1280
    s_waitcnt lgkmcnt(0)
    v_dot2c_f32_bf16 v78, v80, v77
    v_dot2c_f32_bf16 v78, v81, v77
    v_dot2c_f32_bf16 v78, v82, v77
    v_dot2c_f32_bf16 v78, v83, v77
    v_dot2c_f32_bf16 v78, v84, v77
    v_dot2c_f32_bf16 v78, v85, v77
    v_dot2c_f32_bf16 v78, v86, v77
    v_dot2c_f32_bf16 v78, v87, v77
    s_nop 2
    v_mov_b32 v79, v78
    s_nop 0
    s_nop 0
    v_permlane32_swap_b32 v78, v79
    v_add_f32 v78, v78, v79
    v_mov_b32 v79, s9
    s_lshl_b32 s10, s5, 4
    s_add_u32 s10, s10, s4
    s_mul_i32 s10, s10, 768
    s_lshl_b32 s11, s3, 8
    s_add_u32 s10, s10, s11
    s_add_u32 s10, s10, 0xa10000
    v_lshlrev_b32_e64 v76, 3, v2
    s_cmp_eq_u32 s3, 3
    s_cbranch_scc1 L_az_1
    buffer_store_dwordx2 v[78:79], v76, s[64:67], s10 offen sc1
    s_branch L_az2_2
L_az_1:
    v_mov_b32 v80, 0
    v_mov_b32 v82, 0
    v_mov_b32 v81, s9
    v_mov_b32 v83, s9
    s_lshl_b32 s10, s5, 5
    s_add_u32 s10, s10, s4
    s_lshl_b32 s10, s10, 9
    s_add_u32 s10, s10, 0xa40000
    v_lshlrev_b32 v76, 4, v2
    buffer_store_dwordx4 v[80:83], v76, s[64:67], s10 offen sc1
L_az2_2:
    s_lshl_b32 s10, s3, 2
    v_mov_b32 v127, s10
    s_barrier
    ds_read_b128 a[0:3], v72 offset:0
    ds_read_b128 v[88:91], v68 offset:0
    ds_read_b128 v[92:95], v68 offset:4096
    ds_read_b128 a[4:7], v73 offset:0
    ds_read_b128 v[96:99], v69 offset:0
    ds_read_b128 v[100:103], v69 offset:4096
    s_waitcnt lgkmcnt(3)
    v_mfma_f32_32x32x16_bf16 v[36:51], a[0:3], v[88:91], 0
    ds_read_b128 a[8:11], v74 offset:0
    ds_read_b128 v[104:107], v70 offset:0
    v_mfma_f32_32x32x16_bf16 v[52:67], a[0:3], v[92:95], 0
    ds_read_b128 v[108:111], v70 offset:4096
    ds_read_b128 a[12:15], v75 offset:0
    s_waitcnt lgkmcnt(4)
    v_mfma_f32_32x32x16_bf16 v[36:51], a[4:7], v[96:99], v[36:51]
    ds_read_b128 v[112:115], v71 offset:0
    ds_read_b128 v[116:119], v71 offset:4096
    v_mfma_f32_32x32x16_bf16 v[52:67], a[4:7], v[100:103], v[52:67]
    s_waitcnt lgkmcnt(0)
    s_barrier
    v_mfma_f32_32x32x16_bf16 v[36:51], a[8:11], v[104:107], v[36:51]
    ds_read_b128 a[16:19], v72 offset:24576
    ds_read_b128 v[88:91], v68 offset:24576
    s_waitcnt vmcnt(2)
    v_lshlrev_b32 v124, 16, v124
    v_lshlrev_b32_e64 v125, 16, v125
    v_mfma_f32_32x32x16_bf16 v[52:67], a[8:11], v[108:111], v[52:67]
    ds_read_b128 v[92:95], v68 offset:28672
    ds_read_b128 a[20:23], v73 offset:24576
    v_lshlrev_b32_e64 v126, 16, v126
    v_mul_f32 v126, 0x3fb8aa3b, v126
    v_exp_f32_e64 v126, v126
    v_mfma_f32_32x32x16_bf16 v[36:51], a[12:15], v[112:115], v[36:51]
    ds_read_b128 v[96:99], v69 offset:24576
    ds_read_b128 v[100:103], v69 offset:28672
    v_mul_f32_e64 v8, v124, v124
    v_cvt_pk_bf16_f32 v126, v126, v126
    v_fma_f32 v8, v125, v125, v8
    v_mfma_f32_32x32x16_bf16 v[52:67], a[12:15], v[116:119], v[52:67]
    v_lshlrev_b32 v126, 16, v126
    v_rcp_f32 v8, v8
    v_mul_f32 v6, v126, v124
    s_waitcnt lgkmcnt(3)
    v_mfma_f32_32x32x16_bf16 v[36:51], a[16:19], v[88:91], v[36:51]
    ds_read_b128 a[24:27], v74 offset:24576
    ds_read_b128 v[104:107], v70 offset:24576
    v_mul_f32_e64 v7, v126, v125
    v_mul_f32 v6, 0x3fb8aa3b, v6
    v_mul_f32_e64 v7, 0.15915494, v7
    v_mfma_f32_32x32x16_bf16 v[52:67], a[16:19], v[92:95], v[52:67]
    ds_read_b128 v[108:111], v70 offset:28672
    ds_read_b128 a[28:31], v75 offset:24576
    v_exp_f32 v6, v6
    v_rndne_f32 v9, v7
    v_sub_f32 v7, v7, v9
    s_waitcnt lgkmcnt(4)
    v_mfma_f32_32x32x16_bf16 v[36:51], a[20:23], v[96:99], v[36:51]
    ds_read_b128 v[112:115], v71 offset:24576
    ds_read_b128 v[116:119], v71 offset:28672
    v_add_f32 v8, v8, v8
    v_cos_f32 v16, v7
    v_sin_f32_e64 v17, v7
    v_mfma_f32_32x32x16_bf16 v[52:67], a[20:23], v[100:103], v[52:67]
    v_mul_f32 v16, v16, v6
    v_mul_f32 v17, v17, v6
    v_add_f32_e64 v9, -1.0, v16
    s_waitcnt lgkmcnt(0)
    s_barrier
    v_mfma_f32_32x32x16_bf16 v[36:51], a[24:27], v[104:107], v[36:51]
    ds_read_b128 a[32:35], v72 offset:49152
    ds_read_b128 v[88:91], v68 offset:49152
    v_mul_f32 v20, v9, v124
    v_mul_f32 v21, v17, v124
    v_fma_f32 v20, v17, v125, v20
    v_mfma_f32_32x32x16_bf16 v[52:67], a[24:27], v[108:111], v[52:67]
    ds_read_b128 v[92:95], v68 offset:53248
    ds_read_b128 a[36:39], v73 offset:49152
    v_fma_f32 v21, -v9, v125, v21
    v_mul_f32 v20, v20, v8
    v_mul_f32 v21, v21, v8
    v_mfma_f32_32x32x16_bf16 v[36:51], a[28:31], v[112:115], v[36:51]
    ds_read_b128 v[96:99], v69 offset:49152
    ds_read_b128 v[100:103], v69 offset:53248
    v_mul_f32 v6, v17, v17
    v_mul_f32 v7, v16, v17
    v_fma_f32 v120, v16, v16, -v6
    v_mfma_f32_32x32x16_bf16 v[52:67], a[28:31], v[116:119], v[52:67]
    v_add_f32 v121, v7, v7
    v_mul_f32 v6, v121, v121
    v_mul_f32 v7, v120, v121
    s_waitcnt lgkmcnt(3)
    v_mfma_f32_32x32x16_bf16 v[36:51], a[32:35], v[88:91], v[36:51]
    ds_read_b128 a[40:43], v74 offset:49152
    ds_read_b128 v[104:107], v70 offset:49152
    v_fma_f32 v122, v120, v120, -v6
    v_add_f32 v123, v7, v7
    v_mul_f32 v6, v123, v123
    v_mfma_f32_32x32x16_bf16 v[52:67], a[32:35], v[92:95], v[52:67]
    ds_read_b128 v[108:111], v70 offset:53248
    ds_read_b128 a[44:47], v75 offset:49152
    v_mul_f32_e64 v7, v122, v123
    v_fma_f32 v18, v122, v122, -v6
    v_add_f32 v19, v7, v7
    s_waitcnt lgkmcnt(4)
    v_mfma_f32_32x32x16_bf16 v[36:51], a[36:39], v[96:99], v[36:51]
    ds_read_b128 v[112:115], v71 offset:49152
    ds_read_b128 v[116:119], v71 offset:53248
    v_mul_f32 v6, v19, v19
    v_mul_f32 v7, v18, v19
    v_fma_f32 v32, v18, v18, -v6
    v_mfma_f32_32x32x16_bf16 v[52:67], a[36:39], v[100:103], v[52:67]
    v_add_f32 v33, v7, v7
    v_mul_f32 v6, v33, v33
    v_mul_f32_e64 v7, v32, v33
    s_waitcnt lgkmcnt(0)
    s_barrier
    v_add_u32 v68, 73728, v68
    v_add_u32 v72, 73728, v72
    v_add_u32 v69, 73728, v69
    v_add_u32 v73, 73728, v73
    v_add_u32 v70, 73728, v70
    v_add_u32 v74, 73728, v74
    v_add_u32 v71, 73728, v71
    v_add_u32 v75, 73728, v75
    v_mfma_f32_32x32x16_bf16 v[36:51], a[40:43], v[104:107], v[36:51]
    ds_read_b128 a[48:51], v72 offset:0
    ds_read_b128 v[88:91], v68 offset:0
    v_fma_f32 v120, v32, v32, -v6
    v_add_f32 v121, v7, v7
    v_mul_f32 v6, v121, v121
    v_mfma_f32_32x32x16_bf16 v[52:67], a[40:43], v[108:111], v[52:67]
    ds_read_b128 v[92:95], v68 offset:4096
    ds_read_b128 a[52:55], v73 offset:0
    v_mul_f32_e64 v7, v120, v121
    v_fma_f32 v122, v120, v120, -v6
    v_add_f32_e64 v123, v7, v7
    v_mfma_f32_32x32x16_bf16 v[36:51], a[44:47], v[112:115], v[36:51]
    ds_read_b128 v[96:99], v69 offset:0
    ds_read_b128 v[100:103], v69 offset:4096
    s_mov_b32 s12, 0
    s_mov_b32 s13, -1
    v_mov_b32_e64 v8, 1.0
    v_mfma_f32_32x32x16_bf16 v[52:67], a[44:47], v[116:119], v[52:67]
    v_mov_b32 v9, 0
    v_cndmask_b32 v10, v8, v32, s[12:13]
    v_cndmask_b32 v11, v9, v33, s[12:13]
    s_waitcnt lgkmcnt(3)
    v_mfma_f32_32x32x16_bf16 v[36:51], a[48:51], v[88:91], v[36:51]
    ds_read_b128 a[56:59], v74 offset:0
    ds_read_b128 v[104:107], v70 offset:0
    s_bitcmp1_b32 s3, 0
    s_cselect_b64 s[12:13], -1, 0
    v_cndmask_b32 v120, v8, v120, s[12:13]
    v_cndmask_b32 v121, v9, v121, s[12:13]
    s_bitcmp1_b32 s3, 1
    s_cselect_b64 s[12:13], -1, 0
    v_cndmask_b32 v122, v8, v122, s[12:13]
    v_cndmask_b32 v123, v9, v123, s[12:13]
    v_mul_f32_e64 v12, v10, v120
    v_mfma_f32_32x32x16_bf16 v[52:67], a[48:51], v[92:95], v[52:67]
    ds_read_b128 v[108:111], v70 offset:4096
    ds_read_b128 a[60:63], v75 offset:0
    v_mul_f32 v13, v10, v121
    v_fma_f32 v12, -v11, v121, v12
    v_fma_f32 v13, v11, v120, v13
    s_waitcnt lgkmcnt(4)
    v_mfma_f32_32x32x16_bf16 v[36:51], a[52:55], v[96:99], v[36:51]
    ds_read_b128 v[112:115], v71 offset:0
    ds_read_b128 v[116:119], v71 offset:4096
    v_mul_f32 v22, v12, v122
    v_mul_f32 v23, v12, v123
    v_fma_f32 v22, -v13, v123, v22
    v_mfma_f32_32x32x16_bf16 v[52:67], a[52:55], v[100:103], v[52:67]
    v_fma_f32 v23, v13, v122, v23
    s_waitcnt lgkmcnt(0)
    s_barrier
    v_mfma_f32_32x32x16_bf16 v[36:51], a[56:59], v[104:107], v[36:51]
    ds_read_b128 a[64:67], v72 offset:24576
    ds_read_b128 v[88:91], v68 offset:24576
    v_mfma_f32_32x32x16_bf16 v[52:67], a[56:59], v[108:111], v[52:67]
    ds_read_b128 v[92:95], v68 offset:28672
    ds_read_b128 a[68:71], v73 offset:24576
    v_mfma_f32_32x32x16_bf16 v[36:51], a[60:63], v[112:115], v[36:51]
    ds_read_b128 v[96:99], v69 offset:24576
    ds_read_b128 v[100:103], v69 offset:28672
    v_mfma_f32_32x32x16_bf16 v[52:67], a[60:63], v[116:119], v[52:67]
    s_waitcnt lgkmcnt(3)
    v_mfma_f32_32x32x16_bf16 v[36:51], a[64:67], v[88:91], v[36:51]
    ds_read_b128 a[72:75], v74 offset:24576
    ds_read_b128 v[104:107], v70 offset:24576
    v_mfma_f32_32x32x16_bf16 v[52:67], a[64:67], v[92:95], v[52:67]
    ds_read_b128 v[108:111], v70 offset:28672
    ds_read_b128 a[76:79], v75 offset:24576
    s_waitcnt lgkmcnt(4)
    v_mfma_f32_32x32x16_bf16 v[36:51], a[68:71], v[96:99], v[36:51]
    ds_read_b128 v[112:115], v71 offset:24576
    ds_read_b128 v[116:119], v71 offset:28672
    v_mfma_f32_32x32x16_bf16 v[52:67], a[68:71], v[100:103], v[52:67]
    s_waitcnt lgkmcnt(0)
    s_barrier
    v_mfma_f32_32x32x16_bf16 v[36:51], a[72:75], v[104:107], v[36:51]
    ds_read_b128 a[80:83], v72 offset:49152
    ds_read_b128 v[88:91], v68 offset:49152
    v_mfma_f32_32x32x16_bf16 v[52:67], a[72:75], v[108:111], v[52:67]
    ds_read_b128 v[92:95], v68 offset:53248
    ds_read_b128 a[84:87], v73 offset:49152
    v_mfma_f32_32x32x16_bf16 v[36:51], a[76:79], v[112:115], v[36:51]
    ds_read_b128 v[96:99], v69 offset:49152
    ds_read_b128 v[100:103], v69 offset:53248
    v_mfma_f32_32x32x16_bf16 v[52:67], a[76:79], v[116:119], v[52:67]
    s_waitcnt lgkmcnt(3)
    v_mfma_f32_32x32x16_bf16 v[36:51], a[80:83], v[88:91], v[36:51]
    ds_read_b128 a[88:91], v74 offset:49152
    ds_read_b128 v[104:107], v70 offset:49152
    v_mfma_f32_32x32x16_bf16 v[52:67], a[80:83], v[92:95], v[52:67]
    ds_read_b128 v[108:111], v70 offset:53248
    ds_read_b128 a[92:95], v75 offset:49152
    s_waitcnt lgkmcnt(4)
    v_mfma_f32_32x32x16_bf16 v[36:51], a[84:87], v[96:99], v[36:51]
    ds_read_b128 v[112:115], v71 offset:49152
    ds_read_b128 v[116:119], v71 offset:53248
    v_mfma_f32_32x32x16_bf16 v[52:67], a[84:87], v[100:103], v[52:67]
    s_waitcnt lgkmcnt(0)
    s_barrier
    v_subrev_u32 v68, 73728, v68
    v_subrev_u32 v72, 73728, v72
    v_subrev_u32 v69, 73728, v69
    v_subrev_u32 v73, 73728, v73
    v_subrev_u32 v70, 73728, v70
    v_subrev_u32 v74, 73728, v74
    v_subrev_u32 v71, 73728, v71
    v_subrev_u32 v75, 73728, v75
    v_mfma_f32_32x32x16_bf16 v[36:51], a[88:91], v[104:107], v[36:51]
    ds_read_b128 a[96:99], v72 offset:0
    ds_read_b128 v[88:91], v68 offset:0
    v_mfma_f32_32x32x16_bf16 v[52:67], a[88:91], v[108:111], v[52:67]
    ds_read_b128 v[92:95], v68 offset:4096
    ds_read_b128 a[100:103], v73 offset:0
    v_mfma_f32_32x32x16_bf16 v[36:51], a[92:95], v[112:115], v[36:51]
    ds_read_b128 v[96:99], v69 offset:0
    ds_read_b128 v[100:103], v69 offset:4096
    v_mfma_f32_32x32x16_bf16 v[52:67], a[92:95], v[116:119], v[52:67]
    s_waitcnt lgkmcnt(3)
    v_mfma_f32_32x32x16_bf16 v[36:51], a[96:99], v[88:91], v[36:51]
    ds_read_b128 a[104:107], v74 offset:0
    ds_read_b128 v[104:107], v70 offset:0
    v_mfma_f32_32x32x16_bf16 v[52:67], a[96:99], v[92:95], v[52:67]
    ds_read_b128 v[108:111], v70 offset:4096
    ds_read_b128 a[108:111], v75 offset:0
    s_waitcnt lgkmcnt(4)
    v_mfma_f32_32x32x16_bf16 v[36:51], a[100:103], v[96:99], v[36:51]
    ds_read_b128 v[112:115], v71 offset:0
    ds_read_b128 v[116:119], v71 offset:4096
    v_mfma_f32_32x32x16_bf16 v[52:67], a[100:103], v[100:103], v[52:67]
    s_waitcnt lgkmcnt(0)
    s_barrier
    v_mfma_f32_32x32x16_bf16 v[36:51], a[104:107], v[104:107], v[36:51]
    ds_read_b128 a[112:115], v72 offset:24576
    ds_read_b128 v[88:91], v68 offset:24576
    ds_read_b128 v[6:9], v0 offset:9520
    v_mfma_f32_32x32x16_bf16 v[52:67], a[104:107], v[108:111], v[52:67]
    ds_read_b128 v[92:95], v68 offset:28672
    ds_read_b128 a[116:119], v73 offset:24576
    s_waitcnt lgkmcnt(2)
    v_min3_u32 v6, v6, v7, v8
    v_min_u32 v6, v6, v9
    v_cmp_gt_u32 vcc, 1, v6
    s_cbranch_vccnz L_alw_3
L_alwb_4:
    v_lshlrev_b32 v6, 4, v2
    v_mfma_f32_32x32x16_bf16 v[36:51], a[108:111], v[112:115], v[36:51]
    ds_read_b128 v[96:99], v69 offset:24576
    ds_read_b128 v[100:103], v69 offset:28672
    s_lshl_b32 s10, s3, 8
    v_lshl_add_u32 v7, v2, 3, s10
    ds_read_b64 v[12:13], v7 offset:8192
    v_mfma_f32_32x32x16_bf16 v[52:67], a[108:111], v[116:119], v[52:67]
    ds_read_b128 v[76:79], v6 offset:13568
    ds_read_b128 v[80:83], v6 offset:14080
    ds_read_b128 v[84:87], v6 offset:14592
    s_waitcnt lgkmcnt(7)
    v_mfma_f32_32x32x16_bf16 v[36:51], a[112:115], v[88:91], v[36:51]
    ds_read_b128 a[120:123], v74 offset:24576
    ds_read_b128 v[104:107], v70 offset:24576
    s_mov_b32 s10, -1
    s_mov_b32 s11, 0
    s_waitcnt lgkmcnt(5)
    v_mfma_f32_32x32x16_bf16 v[52:67], a[112:115], v[92:95], v[52:67]
    ds_read_b128 v[108:111], v70 offset:28672
    ds_read_b128 a[124:127], v75 offset:24576
    v_and_b32 v6, 0xffff0000, v12
    v_and_b32 v7, 0xffff0000, v13
    v_rcp_f32_e64 v8, v6
    v_mfma_f32_32x32x16_bf16 v[36:51], a[116:119], v[96:99], v[36:51]
    ds_read_b128 v[112:115], v71 offset:24576
    ds_read_b128 v[116:119], v71 offset:28672
    v_max_f32 v7, 0xda24260, v7
    v_lshrrev_b32 v121, 16, v12
    v_rcp_f32 v7, v7
    v_mfma_f32_32x32x16_bf16 v[52:67], a[116:119], v[100:103], v[52:67]
    v_mul_f32_e64 v9, v8, v8
    v_mul_f32 v34, 0xc0135761, v8
    v_lshlrev_b32 v10, 16, v13
    v_mul_f32 v31, v6, v7
    v_max_f32 v10, 0x21800000, v10
    v_mul_f32 v9, v9, v8
    v_mul_f32 v31, v31, v10
    v_mul_f32 v35, 0xbdd2d3e8, v9
    v_and_b32 v120, 0xffff, v12
    v_xor_b32 v120, 0x8000, v120
    v_lshl_or_b32 v120, v120, 16, v120
    v_mov_b32 v122, 0
    v_mov_b32 v123, 0
    s_waitcnt lgkmcnt(6)
    v_add_f32 v76, v76, v77
    v_add_f32 v78, v78, v79
    v_add_f32 v76, v76, v78
    v_cvt_pk_bf16_f32 v77, v76, v76
    v_lshlrev_b32 v77, 16, v77
    v_sub_f32 v78, v76, v77
    v_cvt_pk_bf16_f32 v76, v77, v78
    v_cndmask_b32 v124, 0, v76, s[10:11]
    v_cndmask_b32 v28, 0, v28, s[10:11]
    v_add_f32 v80, v80, v81
    v_add_f32 v82, v82, v83
    v_add_f32_e64 v80, v80, v82
    v_cvt_pk_bf16_f32 v81, v80, v80
    v_lshlrev_b32 v81, 16, v81
    v_sub_f32 v82, v80, v81
    v_cvt_pk_bf16_f32 v80, v81, v82
    v_cndmask_b32 v125, 0, v80, s[10:11]
    v_cndmask_b32 v29, 0, v29, s[10:11]
    v_add_f32 v84, v84, v85
    v_add_f32 v86, v86, v87
    v_add_f32_e64 v84, v84, v86
    v_cvt_pk_bf16_f32 v85, v84, v84
    v_lshlrev_b32 v85, 16, v85
    v_sub_f32 v86, v84, v85
    v_cvt_pk_bf16_f32 v84, v85, v86
    v_cndmask_b32 v126, 0, v84, s[10:11]
    v_cndmask_b32 v30, 0, v30, s[10:11]
    s_waitcnt lgkmcnt(0)
    s_barrier
    s_setprio 1
    ds_read_b64_tr_b16 v[88:89], v14 offset:0
    ds_read_b64_tr_b16 v[90:91], v14 offset:256
    ds_read_b64_tr_b16 v[92:93], v14 offset:1024
    ds_read_b64_tr_b16 v[94:95], v14 offset:1280
    ds_read_b64_tr_b16 v[96:97], v14 offset:2048
    ds_read_b64_tr_b16 v[98:99], v14 offset:2304
    v_mfma_f32_32x32x16_bf16 v[36:51], a[120:123], v[104:107], v[36:51]
    v_mfma_f32_32x32x16_bf16 v[52:67], a[120:123], v[108:111], v[52:67]
    v_mfma_f32_32x32x16_bf16 v[36:51], a[124:127], v[112:115], v[36:51]
    v_mfma_f32_32x32x16_bf16 v[52:67], a[124:127], v[116:119], v[52:67]
    s_nop 10
    v_pk_fma_f32 v[6:7], v[16:17], v[36:37], v[38:39] op_sel_hi:[0,1,1]
    v_pk_fma_f32 v[8:9], v[16:17], v[52:53], v[54:55] op_sel_hi:[0,1,1]
    v_pk_fma_f32 v[6:7], v[16:17], v[52:53], v[6:7] op_sel:[1,0,0] op_sel_hi:[1,1,1] neg_lo:[1,0,0] neg_hi:[1,0,0]
    v_pk_fma_f32 v[8:9], v[16:17], v[36:37], v[8:9] op_sel:[1,0,0] op_sel_hi:[1,1,1]
    v_pk_fma_f32 v[10:11], v[16:17], v[6:7], v[40:41] op_sel_hi:[0,1,1]
    v_pk_fma_f32 v[12:13], v[16:17], v[8:9], v[56:57] op_sel_hi:[0,1,1]
    v_pk_fma_f32 v[10:11], v[16:17], v[8:9], v[10:11] op_sel:[1,0,0] op_sel_hi:[1,1,1] neg_lo:[1,0,0] neg_hi:[1,0,0]
    v_pk_fma_f32 v[12:13], v[16:17], v[6:7], v[12:13] op_sel:[1,0,0] op_sel_hi:[1,1,1]
    v_pk_fma_f32 v[6:7], v[16:17], v[10:11], v[42:43] op_sel_hi:[0,1,1]
    v_pk_fma_f32 v[8:9], v[16:17], v[12:13], v[58:59] op_sel_hi:[0,1,1]
    v_pk_fma_f32 v[6:7], v[16:17], v[12:13], v[6:7] op_sel:[1,0,0] op_sel_hi:[1,1,1] neg_lo:[1,0,0] neg_hi:[1,0,0]
    v_pk_fma_f32 v[8:9], v[16:17], v[10:11], v[8:9] op_sel:[1,0,0] op_sel_hi:[1,1,1]
    v_pk_fma_f32 v[10:11], v[16:17], v[6:7], v[44:45] op_sel_hi:[0,1,1]
    v_pk_fma_f32 v[12:13], v[16:17], v[8:9], v[60:61] op_sel_hi:[0,1,1]
    v_pk_fma_f32 v[10:11], v[16:17], v[8:9], v[10:11] op_sel:[1,0,0] op_sel_hi:[1,1,1] neg_lo:[1,0,0] neg_hi:[1,0,0]
    v_pk_fma_f32 v[12:13], v[16:17], v[6:7], v[12:13] op_sel:[1,0,0] op_sel_hi:[1,1,1]
    v_pk_fma_f32 v[6:7], v[16:17], v[10:11], v[46:47] op_sel_hi:[0,1,1]
    v_pk_fma_f32 v[8:9], v[16:17], v[12:13], v[62:63] op_sel_hi:[0,1,1]
    v_pk_fma_f32 v[6:7], v[16:17], v[12:13], v[6:7] op_sel:[1,0,0] op_sel_hi:[1,1,1] neg_lo:[1,0,0] neg_hi:[1,0,0]
    v_pk_fma_f32 v[8:9], v[16:17], v[10:11], v[8:9] op_sel:[1,0,0] op_sel_hi:[1,1,1]
    v_pk_fma_f32 v[10:11], v[16:17], v[6:7], v[48:49] op_sel_hi:[0,1,1]
    v_pk_fma_f32 v[12:13], v[16:17], v[8:9], v[64:65] op_sel_hi:[0,1,1]
    v_pk_fma_f32 v[10:11], v[16:17], v[8:9], v[10:11] op_sel:[1,0,0] op_sel_hi:[1,1,1] neg_lo:[1,0,0] neg_hi:[1,0,0]
    v_pk_fma_f32 v[12:13], v[16:17], v[6:7], v[12:13] op_sel:[1,0,0] op_sel_hi:[1,1,1]
    v_pk_fma_f32 v[6:7], v[16:17], v[10:11], v[50:51] op_sel_hi:[0,1,1]
    v_pk_fma_f32 v[8:9], v[16:17], v[12:13], v[66:67] op_sel_hi:[0,1,1]
    v_pk_fma_f32 v[6:7], v[16:17], v[12:13], v[6:7] op_sel:[1,0,0] op_sel_hi:[1,1,1] neg_lo:[1,0,0] neg_hi:[1,0,0]
    v_pk_fma_f32 v[8:9], v[16:17], v[10:11], v[8:9] op_sel:[1,0,0] op_sel_hi:[1,1,1]
    v_mov_b32 v24, v6
    v_mov_b32 v25, v8
    v_fma_f32 v86, v18, v6, v7
    v_fma_f32 v87, v18, v8, v9
    v_fma_f32 v86, -v19, v8, v86
    v_fma_f32 v87, v19, v6, v87
    s_lshl_b32 s10, s3, 9
    v_lshl_add_u32 v118, v3, 8, s10
    v_lshl_add_u32 v118, v2, 3, v118
    ds_write_b64 v118, v[86:87] offset:11520
    v_mov_b32 v84, 1
    ds_write_b32 v127, v84 offset:9504
    ds_read_b128 v[10:13], v0 offset:9504
    s_waitcnt lgkmcnt(0)
    v_min3_u32 v10, v10, v11, v12
    v_min_u32 v10, v10, v13
    v_cmp_gt_u32 vcc, 1, v10
    s_cbranch_vccnz L_alw_5
L_alwb_6:
    ds_read_b64 v[104:105], v118 offset:9728
    ds_read_b64 v[106:107], v118 offset:9984
    ds_read_b64 v[108:109], v118 offset:10240
    ds_read_b64 v[110:111], v118 offset:10496
    ds_read_b64 v[112:113], v118 offset:10752
    ds_read_b64 v[114:115], v118 offset:11008
    ds_read_b64 v[116:117], v118 offset:11264
    s_lshl_b32 s10, s5, 5
    s_add_u32 s10, s10, s4
    s_lshl_b32 s10, s10, 9
    s_add_u32 s10, s10, 0xa42000
    v_lshlrev_b32_e64 v119, 4, v2
    s_waitcnt lgkmcnt(0)
    v_fma_f32 v84, v32, v104, v106
    v_fma_f32 v85, v32, v105, v107
    v_fma_f32 v84, -v33, v105, v84
    v_fma_f32 v85, v33, v104, v85
    v_fma_f32 v26, v32, v84, v108
    v_fma_f32 v27, v32, v85, v109
    v_fma_f32 v26, -v33, v85, v26
    v_fma_f32 v27, v33, v84, v27
    v_fma_f32 v84, v32, v26, v110
    v_fma_f32 v85, v32, v27, v111
    v_fma_f32 v84, -v33, v27, v84
    v_fma_f32 v85, v33, v26, v85
    v_fma_f32 v26, v32, v84, v112
    v_fma_f32 v27, v32, v85, v113
    v_fma_f32 v26, -v33, v85, v26
    v_fma_f32 v27, v33, v84, v27
    v_fma_f32 v84, v32, v26, v114
    v_fma_f32 v85, v32, v27, v115
    v_fma_f32 v84, -v33, v27, v84
    v_fma_f32 v85, v33, v26, v85
    v_fma_f32 v26, v32, v84, v116
    v_fma_f32 v27, v32, v85, v117
    v_fma_f32 v26, -v33, v85, v26
    v_fma_f32 v27, v33, v84, v27
    v_fma_f32 v104, v32, v26, v86
    v_fma_f32 v106, v32, v27, v87
    v_fma_f32 v104, -v33, v27, v104
    v_fma_f32 v106, v33, v26, v106
    v_mov_b32 v105, s9
    v_mov_b32 v107, s9
    s_cmp_lg_u32 s3, 3
    s_cbranch_scc1 L_ape_7
    s_mov_b32 exec_lo, 0
    buffer_store_dwordx4 v[104:107], v119, s[64:67], s10 offen sc1
    s_mov_b32 exec_lo, -1
L_ape_7:
    s_add_u32 s97, s99, 4096
    v_mfma_f32_32x32x16_bf16 v[68:83], v[88:91], a[0:3], 0
    ds_read_b64_tr_b16 v[100:101], v14 offset:3072
    ds_read_b64_tr_b16 v[102:103], v14 offset:3328
    v_mfma_f32_32x32x16_bf16 v[68:83], v[92:95], a[4:7], v[68:83]
    ds_read_b64_tr_b16 v[88:89], v14 offset:4096
    ds_read_b64_tr_b16 v[90:91], v14 offset:4352
    ds_read_b128 v[6:9], v0 offset:9472
    v_mfma_f32_32x32x16_bf16 v[68:83], v[96:99], a[8:11], v[68:83]
    ds_read_b64_tr_b16 v[92:93], v14 offset:5120
    ds_read_b64_tr_b16 v[94:95], v14 offset:5376
    s_waitcnt lgkmcnt(5)
    v_mfma_f32_32x32x16_bf16 v[68:83], v[100:103], a[12:15], v[68:83]
    ds_read_b64_tr_b16 v[96:97], v14 offset:6144
    ds_read_b64_tr_b16 v[98:99], v14 offset:6400
    s_waitcnt lgkmcnt(5)
    v_mfma_f32_32x32x16_bf16 v[68:83], v[88:91], a[16:19], v[68:83]
    ds_read_b64_tr_b16 v[100:101], v14 offset:7168
    ds_read_b64_tr_b16 v[102:103], v14 offset:7424
    s_waitcnt lgkmcnt(6)
    v_min3_u32 v6, v6, v7, v8
    v_min_u32 v6, v6, v9
    v_cmp_gt_u32_e64 vcc, 6, v6
    s_cbranch_vccnz L_alw_8
L_alwb_9:
    s_waitcnt lgkmcnt(4)
    v_mfma_f32_32x32x16_bf16 v[68:83], v[92:95], a[20:23], v[68:83]
    ds_read_b64_tr_b16 v[88:89], v14 offset:8192
    ds_read_b64_tr_b16 v[90:91], v14 offset:8448
    s_waitcnt lgkmcnt(4)
    v_mfma_f32_32x32x16_bf16 v[68:83], v[96:99], a[24:27], v[68:83]
    ds_read_b64_tr_b16 v[92:93], v14 offset:9216
    ds_read_b64_tr_b16 v[94:95], v14 offset:9472
    s_waitcnt lgkmcnt(4)
    v_mfma_f32_32x32x16_bf16 v[68:83], v[100:103], a[28:31], v[68:83]
    ds_read_b64_tr_b16 v[96:97], v14 offset:10240
    ds_read_b64_tr_b16 v[98:99], v14 offset:10496
    s_waitcnt lgkmcnt(4)
    v_mfma_f32_32x32x16_bf16 v[68:83], v[88:91], a[32:35], v[68:83]
    ds_read_b64_tr_b16 v[100:101], v14 offset:11264
    ds_read_b64_tr_b16 v[102:103], v14 offset:11520
    s_waitcnt lgkmcnt(4)
    v_mfma_f32_32x32x16_bf16 v[68:83], v[92:95], a[36:39], v[68:83]
    ds_read_b64_tr_b16 v[88:89], v14 offset:12288
    ds_read_b64_tr_b16 v[90:91], v14 offset:12544
    ds_read_b128 v[6:9], v0 offset:9472
    s_waitcnt lgkmcnt(5)
    v_mfma_f32_32x32x16_bf16 v[68:83], v[96:99], a[40:43], v[68:83]
    ds_read_b64_tr_b16 v[92:93], v14 offset:13312
    ds_read_b64_tr_b16 v[94:95], v14 offset:13568
    s_waitcnt lgkmcnt(5)
    v_mfma_f32_32x32x16_bf16 v[68:83], v[100:103], a[44:47], v[68:83]
    ds_read_b64_tr_b16 v[96:97], v14 offset:14336
    ds_read_b64_tr_b16 v[98:99], v14 offset:14592
    s_waitcnt lgkmcnt(5)
    v_mfma_f32_32x32x16_bf16 v[68:83], v[88:91], a[48:51], v[68:83]
    ds_read_b64_tr_b16 v[100:101], v14 offset:15360
    ds_read_b64_tr_b16 v[102:103], v14 offset:15616
    s_waitcnt lgkmcnt(6)
    v_min3_u32 v6, v6, v7, v8
    v_min_u32 v6, v6, v9
    v_cmp_gt_u32 vcc, 9, v6
    s_cbranch_vccnz L_alw_10
L_alwb_11:
    s_waitcnt lgkmcnt(4)
    v_mfma_f32_32x32x16_bf16 v[68:83], v[92:95], a[52:55], v[68:83]
    ds_read_b64_tr_b16 v[88:89], v14 offset:16384
    ds_read_b64_tr_b16 v[90:91], v14 offset:16640
    s_waitcnt lgkmcnt(4)
    v_mfma_f32_32x32x16_bf16 v[68:83], v[96:99], a[56:59], v[68:83]
    ds_read_b64_tr_b16 v[92:93], v14 offset:17408
    ds_read_b64_tr_b16 v[94:95], v14 offset:17664
    s_waitcnt lgkmcnt(4)
    v_mfma_f32_32x32x16_bf16 v[68:83], v[100:103], a[60:63], v[68:83]
    ds_read_b64_tr_b16 v[96:97], v14 offset:18432
    ds_read_b64_tr_b16 v[98:99], v14 offset:18688
    s_waitcnt lgkmcnt(4)
    v_mfma_f32_32x32x16_bf16 v[68:83], v[88:91], a[64:67], v[68:83]
    ds_read_b64_tr_b16 v[100:101], v14 offset:19456
    ds_read_b64_tr_b16 v[102:103], v14 offset:19712
    s_waitcnt lgkmcnt(4)
    v_mfma_f32_32x32x16_bf16 v[68:83], v[92:95], a[68:71], v[68:83]
    ds_read_b64_tr_b16 v[88:89], v14 offset:20480
    ds_read_b64_tr_b16 v[90:91], v14 offset:20736
    ds_read_b128 v[6:9], v0 offset:9472
    s_waitcnt lgkmcnt(5)
    v_mfma_f32_32x32x16_bf16 v[68:83], v[96:99], a[72:75], v[68:83]
    ds_read_b64_tr_b16 v[92:93], v14 offset:21504
    ds_read_b64_tr_b16 v[94:95], v14 offset:21760
    s_waitcnt lgkmcnt(5)
    v_mfma_f32_32x32x16_bf16 v[68:83], v[100:103], a[76:79], v[68:83]
    ds_read_b64_tr_b16 v[96:97], v14 offset:22528
    ds_read_b64_tr_b16 v[98:99], v14 offset:22784
    s_waitcnt lgkmcnt(5)
    v_mfma_f32_32x32x16_bf16 v[68:83], v[88:91], a[80:83], v[68:83]
    ds_read_b64_tr_b16 v[100:101], v14 offset:23552
    ds_read_b64_tr_b16 v[102:103], v14 offset:23808
    s_waitcnt lgkmcnt(6)
    v_min3_u32 v6, v6, v7, v8
    v_min_u32 v6, v6, v9
    v_cmp_gt_u32 vcc, 12, v6
    s_cbranch_vccnz L_alw_12
L_alwb_13:
    s_waitcnt lgkmcnt(4)
    v_mfma_f32_32x32x16_bf16 v[68:83], v[92:95], a[84:87], v[68:83]
    ds_read_b64_tr_b16 v[88:89], v14 offset:24576
    ds_read_b64_tr_b16 v[90:91], v14 offset:24832
    s_waitcnt lgkmcnt(4)
    v_mfma_f32_32x32x16_bf16 v[68:83], v[96:99], a[88:91], v[68:83]
    ds_read_b64_tr_b16 v[92:93], v14 offset:25600
    ds_read_b64_tr_b16 v[94:95], v14 offset:25856
    s_waitcnt lgkmcnt(4)
    v_mfma_f32_32x32x16_bf16 v[68:83], v[100:103], a[92:95], v[68:83]
    ds_read_b64_tr_b16 v[96:97], v14 offset:26624
    ds_read_b64_tr_b16 v[98:99], v14 offset:26880
    s_waitcnt lgkmcnt(4)
    v_mfma_f32_32x32x16_bf16 v[68:83], v[88:91], a[96:99], v[68:83]
    ds_read_b64_tr_b16 v[100:101], v14 offset:27648
    ds_read_b64_tr_b16 v[102:103], v14 offset:27904
    s_waitcnt lgkmcnt(4)
    v_mfma_f32_32x32x16_bf16 v[68:83], v[92:95], a[100:103], v[68:83]
    ds_read_b64_tr_b16 v[88:89], v14 offset:28672
    ds_read_b64_tr_b16 v[90:91], v14 offset:28928
    s_waitcnt lgkmcnt(4)
    v_mfma_f32_32x32x16_bf16 v[68:83], v[96:99], a[104:107], v[68:83]
    ds_read_b64_tr_b16 v[92:93], v14 offset:29696
    ds_read_b64_tr_b16 v[94:95], v14 offset:29952
    s_waitcnt lgkmcnt(4)
    v_mfma_f32_32x32x16_bf16 v[68:83], v[100:103], a[108:111], v[68:83]
    ds_read_b64_tr_b16 v[96:97], v14 offset:30720
    ds_read_b64_tr_b16 v[98:99], v14 offset:30976
    s_waitcnt lgkmcnt(4)
    v_mfma_f32_32x32x16_bf16 v[68:83], v[88:91], a[112:115], v[68:83]
    ds_read_b64_tr_b16 v[100:101], v14 offset:31744
    ds_read_b64_tr_b16 v[102:103], v14 offset:32000
    s_waitcnt lgkmcnt(4)
    v_mfma_f32_32x32x16_bf16 v[68:83], v[92:95], a[116:119], v[68:83]
    s_waitcnt lgkmcnt(2)
    v_mfma_f32_32x32x16_bf16 v[68:83], v[96:99], a[120:123], v[68:83]
    s_waitcnt lgkmcnt(0)
    v_mfma_f32_32x32x16_bf16 v[68:83], v[100:103], a[124:127], v[68:83]
    v_mov_b32_e64 v84, 9
    ds_write_b32 v127, v84 offset:9488
    v_mov_b32 v10, v124
    v_mov_b32 v11, v28
    v_mov_b32 v12, 0
    v_mov_b32 v13, 0
    s_nop 1
    v_mfma_f32_32x32x16_bf16 v[68:83], v[10:13], v[120:123], v[68:83]
    s_nop 11
    v_pk_mul_f32 v[6:7], v[68:69], v[68:69]
    v_pk_mul_f32 v[8:9], v[70:71], v[70:71]
    v_pk_mul_f32 v[10:11], v[72:73], v[72:73]
    v_pk_mul_f32 v[12:13], v[74:75], v[74:75]
    v_pk_fma_f32 v[6:7], v[34:35], v[6:7], v[34:35] op_sel:[1,0,0] op_sel_hi:[1,1,0]
    v_pk_fma_f32 v[8:9], v[34:35], v[8:9], v[34:35] op_sel:[1,0,0] op_sel_hi:[1,1,0]
    v_pk_fma_f32 v[10:11], v[34:35], v[10:11], v[34:35] op_sel:[1,0,0] op_sel_hi:[1,1,0]
    v_pk_fma_f32 v[12:13], v[34:35], v[12:13], v[34:35] op_sel:[1,0,0] op_sel_hi:[1,1,0]
    v_pk_mul_f32 v[6:7], v[6:7], v[68:69]
    v_pk_mul_f32 v[8:9], v[8:9], v[70:71]
    v_pk_mul_f32 v[10:11], v[10:11], v[72:73]
    v_pk_mul_f32 v[12:13], v[12:13], v[74:75]
    v_exp_f32 v6, v6
    v_exp_f32 v7, v7
    v_exp_f32 v8, v8
    v_exp_f32 v9, v9
    v_exp_f32 v10, v10
    v_exp_f32 v11, v11
    v_exp_f32 v12, v12
    v_exp_f32 v13, v13
    v_pk_fma_f32 v[6:7], v[30:31], v[6:7], v[30:31] op_sel:[1,0,1] op_sel_hi:[1,1,1]
    v_pk_fma_f32 v[8:9], v[30:31], v[8:9], v[30:31] op_sel:[1,0,1] op_sel_hi:[1,1,1]
    v_pk_fma_f32 v[10:11], v[30:31], v[10:11], v[30:31] op_sel:[1,0,1] op_sel_hi:[1,1,1]
    v_pk_fma_f32 v[12:13], v[30:31], v[12:13], v[30:31] op_sel:[1,0,1] op_sel_hi:[1,1,1]
    v_rcp_f32 v6, v6
    v_rcp_f32 v7, v7
    v_rcp_f32 v8, v8
    v_rcp_f32 v9, v9
    v_rcp_f32 v10, v10
    v_rcp_f32 v11, v11
    v_rcp_f32 v12, v12
    v_rcp_f32 v13, v13
    v_pk_mul_f32 v[6:7], v[6:7], v[68:69]
    v_pk_mul_f32 v[8:9], v[8:9], v[70:71]
    v_pk_mul_f32 v[10:11], v[10:11], v[72:73]
    v_pk_mul_f32 v[12:13], v[12:13], v[74:75]
    v_cvt_pk_bf16_f32 v68, v6, v7
    v_cvt_pk_bf16_f32 v69, v8, v9
    v_cvt_pk_bf16_f32 v70, v10, v11
    v_cvt_pk_bf16_f32 v71, v12, v13
    buffer_store_dwordx4 v[68:71], v4, s[64:67], s99 offen offset:0 sc1
    ds_read_b64_tr_b16 v[88:89], v14 offset:32768
    ds_read_b64_tr_b16 v[90:91], v14 offset:33024
    ds_read_b64_tr_b16 v[92:93], v14 offset:33792
    ds_read_b64_tr_b16 v[94:95], v14 offset:34048
    ds_read_b64_tr_b16 v[96:97], v14 offset:34816
    ds_read_b64_tr_b16 v[98:99], v14 offset:35072
    ds_read_b64_tr_b16 v[100:101], v14 offset:35840
    ds_read_b64_tr_b16 v[102:103], v14 offset:36096
    ds_read_b64_tr_b16 v[104:105], v14 offset:36864
    ds_read_b64_tr_b16 v[106:107], v14 offset:37120
    ds_read_b64_tr_b16 v[108:109], v14 offset:37888
    ds_read_b64_tr_b16 v[110:111], v14 offset:38144
    ds_read_b64_tr_b16 v[112:113], v14 offset:38912
    ds_read_b64_tr_b16 v[114:115], v14 offset:39168
    v_pk_mul_f32 v[6:7], v[76:77], v[76:77]
    v_pk_mul_f32 v[8:9], v[78:79], v[78:79]
    v_pk_mul_f32 v[10:11], v[80:81], v[80:81]
    v_pk_mul_f32 v[12:13], v[82:83], v[82:83]
    v_pk_fma_f32 v[6:7], v[34:35], v[6:7], v[34:35] op_sel:[1,0,0] op_sel_hi:[1,1,0]
    v_pk_fma_f32 v[8:9], v[34:35], v[8:9], v[34:35] op_sel:[1,0,0] op_sel_hi:[1,1,0]
    v_pk_fma_f32 v[10:11], v[34:35], v[10:11], v[34:35] op_sel:[1,0,0] op_sel_hi:[1,1,0]
    v_pk_fma_f32 v[12:13], v[34:35], v[12:13], v[34:35] op_sel:[1,0,0] op_sel_hi:[1,1,0]
    v_pk_mul_f32 v[6:7], v[6:7], v[76:77]
    v_pk_mul_f32 v[8:9], v[8:9], v[78:79]
    v_pk_mul_f32 v[10:11], v[10:11], v[80:81]
    v_pk_mul_f32 v[12:13], v[12:13], v[82:83]
    v_exp_f32 v6, v6
    v_exp_f32 v7, v7
    v_exp_f32 v8, v8
    v_exp_f32 v9, v9
    v_exp_f32 v10, v10
    v_exp_f32 v11, v11
    v_exp_f32 v12, v12
    v_exp_f32 v13, v13
    v_pk_fma_f32 v[6:7], v[30:31], v[6:7], v[30:31] op_sel:[1,0,1] op_sel_hi:[1,1,1]
    v_pk_fma_f32 v[8:9], v[30:31], v[8:9], v[30:31] op_sel:[1,0,1] op_sel_hi:[1,1,1]
    v_pk_fma_f32 v[10:11], v[30:31], v[10:11], v[30:31] op_sel:[1,0,1] op_sel_hi:[1,1,1]
    v_pk_fma_f32 v[12:13], v[30:31], v[12:13], v[30:31] op_sel:[1,0,1] op_sel_hi:[1,1,1]
    v_rcp_f32 v6, v6
    v_rcp_f32 v7, v7
    v_rcp_f32 v8, v8
    v_rcp_f32 v9, v9
    v_rcp_f32 v10, v10
    v_rcp_f32 v11, v11
    v_rcp_f32 v12, v12
    v_rcp_f32 v13, v13
    v_pk_mul_f32 v[6:7], v[6:7], v[76:77]
    v_pk_mul_f32 v[8:9], v[8:9], v[78:79]
    v_pk_mul_f32 v[10:11], v[10:11], v[80:81]
    v_pk_mul_f32 v[12:13], v[12:13], v[82:83]
    v_cvt_pk_bf16_f32 v76, v6, v7
    v_cvt_pk_bf16_f32 v77, v8, v9
    v_cvt_pk_bf16_f32 v78, v10, v11
    v_cvt_pk_bf16_f32 v79, v12, v13
    buffer_store_dwordx4 v[76:79], v4, s[64:67], s99 offen offset:1024 sc1
    s_waitcnt lgkmcnt(6)
    s_nop 0
    v_mfma_f32_32x32x16_bf16 v[68:83], v[88:91], a[0:3], 0
    ds_read_b64_tr_b16 v[116:117], v14 offset:39936
    ds_read_b64_tr_b16 v[118:119], v14 offset:40192
    v_mul_f32 v6, v21, v36
    v_mul_f32 v7, v21, v37
    v_mul_f32_e64 v36, v20, v36
    v_mfma_f32_32x32x16_bf16 v[68:83], v[92:95], a[4:7], v[68:83]
    ds_read_b64_tr_b16 v[88:89], v14 offset:40960
    ds_read_b64_tr_b16 v[90:91], v14 offset:41216
    v_mul_f32_e64 v37, v20, v37
    v_fma_f32 v36, -v21, v52, v36
    v_fma_f32 v37, -v21, v53, v37
    v_mfma_f32_32x32x16_bf16 v[68:83], v[96:99], a[8:11], v[68:83]
    ds_read_b64_tr_b16 v[92:93], v14 offset:41984
    ds_read_b64_tr_b16 v[94:95], v14 offset:42240
    v_fma_f32 v52, -v20, v52, -v6
    v_fma_f32 v53, -v20, v53, -v7
    v_mul_f32_e64 v6, v21, v38
    v_mfma_f32_32x32x16_bf16 v[68:83], v[100:103], a[12:15], v[68:83]
    ds_read_b64_tr_b16 v[96:97], v14 offset:43008
    ds_read_b64_tr_b16 v[98:99], v14 offset:43264
    v_mul_f32 v7, v21, v39
    v_mul_f32 v38, v20, v38
    v_mul_f32 v39, v20, v39
    s_waitcnt lgkmcnt(6)
    v_mfma_f32_32x32x16_bf16 v[68:83], v[104:107], a[16:19], v[68:83]
    ds_read_b64_tr_b16 v[100:101], v14 offset:44032
    ds_read_b64_tr_b16 v[102:103], v14 offset:44288
    v_fma_f32 v38, -v21, v54, v38
    v_fma_f32 v39, -v21, v55, v39
    v_fma_f32 v54, -v20, v54, -v6
    v_mfma_f32_32x32x16_bf16 v[68:83], v[108:111], a[20:23], v[68:83]
    ds_read_b64_tr_b16 v[104:105], v14 offset:45056
    ds_read_b64_tr_b16 v[106:107], v14 offset:45312
    v_fma_f32 v55, -v20, v55, -v7
    v_mul_f32 v6, v21, v40
    v_mul_f32 v7, v21, v41
    v_mfma_f32_32x32x16_bf16 v[68:83], v[112:115], a[24:27], v[68:83]
    ds_read_b64_tr_b16 v[108:109], v14 offset:46080
    ds_read_b64_tr_b16 v[110:111], v14 offset:46336
    v_mul_f32 v40, v20, v40
    v_mul_f32 v41, v20, v41
    v_fma_f32 v40, -v21, v56, v40
    v_mfma_f32_32x32x16_bf16 v[68:83], v[116:119], a[28:31], v[68:83]
    ds_read_b64_tr_b16 v[112:113], v14 offset:47104
    ds_read_b64_tr_b16 v[114:115], v14 offset:47360
    v_fma_f32 v41, -v21, v57, v41
    v_fma_f32 v56, -v20, v56, -v6
    v_fma_f32 v57, -v20, v57, -v7
    s_waitcnt lgkmcnt(6)
    v_mfma_f32_32x32x16_bf16 v[68:83], v[88:91], a[32:35], v[68:83]
    ds_read_b64_tr_b16 v[116:117], v14 offset:48128
    ds_read_b64_tr_b16 v[118:119], v14 offset:48384
    v_mul_f32 v6, v21, v42
    v_mul_f32 v7, v21, v43
    v_mul_f32 v42, v20, v42
    v_mfma_f32_32x32x16_bf16 v[68:83], v[92:95], a[36:39], v[68:83]
    ds_read_b64_tr_b16 v[88:89], v14 offset:49152
    ds_read_b64_tr_b16 v[90:91], v14 offset:49408
    v_mul_f32_e64 v43, v20, v43
    v_fma_f32 v42, -v21, v58, v42
    v_fma_f32 v43, -v21, v59, v43
    v_mfma_f32_32x32x16_bf16 v[68:83], v[96:99], a[40:43], v[68:83]
    ds_read_b64_tr_b16 v[92:93], v14 offset:50176
    ds_read_b64_tr_b16 v[94:95], v14 offset:50432
    v_fma_f32 v58, -v20, v58, -v6
    v_fma_f32 v59, -v20, v59, -v7
    v_mul_f32_e64 v6, v21, v44
    v_mfma_f32_32x32x16_bf16 v[68:83], v[100:103], a[44:47], v[68:83]
    ds_read_b64_tr_b16 v[96:97], v14 offset:51200
    ds_read_b64_tr_b16 v[98:99], v14 offset:51456
    v_mul_f32 v7, v21, v45
    v_mul_f32 v44, v20, v44
    v_mul_f32 v45, v20, v45
    s_waitcnt lgkmcnt(6)
    v_mfma_f32_32x32x16_bf16 v[68:83], v[104:107], a[48:51], v[68:83]
    ds_read_b64_tr_b16 v[100:101], v14 offset:52224
    ds_read_b64_tr_b16 v[102:103], v14 offset:52480
    v_fma_f32 v44, -v21, v60, v44
    v_fma_f32 v45, -v21, v61, v45
    v_fma_f32 v60, -v20, v60, -v6
    v_mfma_f32_32x32x16_bf16 v[68:83], v[108:111], a[52:55], v[68:83]
    ds_read_b64_tr_b16 v[104:105], v14 offset:53248
    ds_read_b64_tr_b16 v[106:107], v14 offset:53504
    v_fma_f32 v61, -v20, v61, -v7
    v_mul_f32 v6, v21, v46
    v_mul_f32 v7, v21, v47
    v_mfma_f32_32x32x16_bf16 v[68:83], v[112:115], a[56:59], v[68:83]
    ds_read_b64_tr_b16 v[108:109], v14 offset:54272
    ds_read_b64_tr_b16 v[110:111], v14 offset:54528
    v_mul_f32 v46, v20, v46
    v_mul_f32 v47, v20, v47
    v_fma_f32 v46, -v21, v62, v46
    v_mfma_f32_32x32x16_bf16 v[68:83], v[116:119], a[60:63], v[68:83]
    ds_read_b64_tr_b16 v[112:113], v14 offset:55296
    ds_read_b64_tr_b16 v[114:115], v14 offset:55552
    v_fma_f32 v47, -v21, v63, v47
    v_fma_f32 v62, -v20, v62, -v6
    v_fma_f32 v63, -v20, v63, -v7
    s_waitcnt lgkmcnt(6)
    v_mfma_f32_32x32x16_bf16 v[68:83], v[88:91], a[64:67], v[68:83]
    ds_read_b64_tr_b16 v[116:117], v14 offset:56320
    ds_read_b64_tr_b16 v[118:119], v14 offset:56576
    v_mul_f32 v6, v21, v48
    v_mul_f32 v7, v21, v49
    v_mul_f32 v48, v20, v48
    v_mfma_f32_32x32x16_bf16 v[68:83], v[92:95], a[68:71], v[68:83]
    ds_read_b64_tr_b16 v[88:89], v14 offset:57344
    ds_read_b64_tr_b16 v[90:91], v14 offset:57600
    v_mul_f32_e64 v49, v20, v49
    v_fma_f32 v48, -v21, v64, v48
    v_fma_f32 v49, -v21, v65, v49
    v_mfma_f32_32x32x16_bf16 v[68:83], v[96:99], a[72:75], v[68:83]
    ds_read_b64_tr_b16 v[92:93], v14 offset:58368
    ds_read_b64_tr_b16 v[94:95], v14 offset:58624
    v_fma_f32 v64, -v20, v64, -v6
    v_fma_f32 v65, -v20, v65, -v7
    v_mul_f32_e64 v6, v21, v50
    v_mfma_f32_32x32x16_bf16 v[68:83], v[100:103], a[76:79], v[68:83]
    ds_read_b64_tr_b16 v[96:97], v14 offset:59392
    ds_read_b64_tr_b16 v[98:99], v14 offset:59648
    v_mul_f32 v7, v21, v51
    v_mul_f32 v50, v20, v50
    v_mul_f32_e64 v51, v20, v51
    s_waitcnt vmcnt(0)
    s_add_u32 s1, s101, 0
    v_mov_b32 v84, s8
    s_mov_b64 exec, 1
    buffer_store_dword v84, v0, s[64:67], s1 offen sc1
    s_mov_b64 exec, -1
    s_waitcnt lgkmcnt(6)
    v_mfma_f32_32x32x16_bf16 v[68:83], v[104:107], a[80:83], v[68:83]
    ds_read_b64_tr_b16 v[100:101], v14 offset:60416
    ds_read_b64_tr_b16 v[102:103], v14 offset:60672
    v_fma_f32 v50, -v21, v66, v50
    v_fma_f32 v51, -v21, v67, v51
    v_fma_f32 v66, -v20, v66, -v6
    v_mfma_f32_32x32x16_bf16 v[68:83], v[108:111], a[84:87], v[68:83]
    ds_read_b64_tr_b16 v[104:105], v14 offset:61440
    ds_read_b64_tr_b16 v[106:107], v14 offset:61696
    v_fma_f32 v67, -v20, v67, -v7
    s_lshl_b32 s10, s3, 11
    v_bfe_u32 v32, v2, 1, 2
    v_mfma_f32_32x32x16_bf16 v[68:83], v[112:115], a[88:91], v[68:83]
    ds_read_b64_tr_b16 v[108:109], v14 offset:62464
    ds_read_b64_tr_b16 v[110:111], v14 offset:62720
    v_lshlrev_b32 v33, 1, v3
    v_xor_b32 v32, v32, v33
    v_lshlrev_b32 v32, 4, v32
    v_mfma_f32_32x32x16_bf16 v[68:83], v[116:119], a[92:95], v[68:83]
    ds_read_b64_tr_b16 v[112:113], v14 offset:63488
    ds_read_b64_tr_b16 v[114:115], v14 offset:63744
    v_lshl_add_u32 v32, v2, 6, v32
    v_add_u32_e64 v32, s10, v32
    v_xor_b32 v33, 16, v32
    s_waitcnt lgkmcnt(6)
    v_mfma_f32_32x32x16_bf16 v[68:83], v[88:91], a[96:99], v[68:83]
    ds_read_b64_tr_b16 v[116:117], v14 offset:64512
    ds_read_b64_tr_b16 v[118:119], v14 offset:64768
    v_and_b32_e64 v86, 1, v1
    v_bfe_u32 v87, v1, 4, 1
    v_lshl_add_u32 v86, v86, 1, v87
    v_mfma_f32_32x32x16_bf16 v[68:83], v[92:95], a[100:103], v[68:83]
    ds_read_b64_tr_b16 v[88:89], v15 offset:0
    ds_read_b64_tr_b16 v[90:91], v15 offset:256
    v_bfe_u32 v87, v1, 3, 1
    v_xor_b32 v86, v86, v87
    v_lshlrev_b32 v86, 4, v86
    v_mfma_f32_32x32x16_bf16 v[68:83], v[96:99], a[104:107], v[68:83]
    ds_read_b64_tr_b16 v[92:93], v15 offset:1024
    ds_read_b64_tr_b16 v[94:95], v15 offset:1280
    v_bfe_u32 v87, v1, 1, 1
    v_lshl_add_u32 v86, v87, 3, v86
    v_bfe_u32 v87, v1, 2, 2
    v_mfma_f32_32x32x16_bf16 v[68:83], v[100:103], a[108:111], v[68:83]
    ds_read_b64_tr_b16 v[96:97], v15 offset:2048
    ds_read_b64_tr_b16 v[98:99], v15 offset:2304
    v_lshl_add_u32 v87, v3, 3, v87
    v_lshl_add_u32 v86, v87, 6, v86
    v_add_u32 v86, s10, v86
    s_waitcnt lgkmcnt(6)
    v_mfma_f32_32x32x16_bf16 v[68:83], v[104:107], a[112:115], v[68:83]
    ds_read_b64_tr_b16 v[100:101], v15 offset:3072
    ds_read_b64_tr_b16 v[102:103], v15 offset:3328
    v_xor_b32 v87, 32, v86
    v_lshlrev_b32 v85, 3, v2
    v_mfma_f32_32x32x16_bf16 v[68:83], v[108:111], a[116:119], v[68:83]
    ds_read_b64_tr_b16 v[104:105], v15 offset:4096
    ds_read_b64_tr_b16 v[106:107], v15 offset:4352
    v_mfma_f32_32x32x16_bf16 v[68:83], v[112:115], a[120:123], v[68:83]
    ds_read_b64_tr_b16 v[108:109], v15 offset:5120
    ds_read_b64_tr_b16 v[110:111], v15 offset:5376
    v_mfma_f32_32x32x16_bf16 v[68:83], v[116:119], a[124:127], v[68:83]
    v_mov_b32_e64 v84, 10
    ds_write_b32 v127, v84 offset:9488
    ds_read_b64_tr_b16 v[112:113], v15 offset:6144
    ds_read_b64_tr_b16 v[114:115], v15 offset:6400
    v_mov_b32 v10, v125
    v_mov_b32 v11, v29
    v_mov_b32 v12, 0
    v_mov_b32 v13, 0
    s_nop 1
    v_mfma_f32_32x32x16_bf16 v[68:83], v[10:13], v[120:123], v[68:83]
    s_nop 11
    v_pk_mul_f32 v[6:7], v[68:69], v[68:69]
    v_pk_mul_f32 v[8:9], v[70:71], v[70:71]
    v_pk_mul_f32 v[10:11], v[72:73], v[72:73]
    v_pk_mul_f32 v[12:13], v[74:75], v[74:75]
    v_pk_fma_f32 v[6:7], v[34:35], v[6:7], v[34:35] op_sel:[1,0,0] op_sel_hi:[1,1,0]
    v_pk_fma_f32 v[8:9], v[34:35], v[8:9], v[34:35] op_sel:[1,0,0] op_sel_hi:[1,1,0]
    v_pk_fma_f32 v[10:11], v[34:35], v[10:11], v[34:35] op_sel:[1,0,0] op_sel_hi:[1,1,0]
    v_pk_fma_f32 v[12:13], v[34:35], v[12:13], v[34:35] op_sel:[1,0,0] op_sel_hi:[1,1,0]
    v_pk_mul_f32 v[6:7], v[6:7], v[68:69]
    v_pk_mul_f32 v[8:9], v[8:9], v[70:71]
    v_pk_mul_f32 v[10:11], v[10:11], v[72:73]
    v_pk_mul_f32 v[12:13], v[12:13], v[74:75]
    v_exp_f32 v6, v6
    v_exp_f32 v7, v7
    v_exp_f32 v8, v8
    v_exp_f32 v9, v9
    v_exp_f32 v10, v10
    v_exp_f32 v11, v11
    v_exp_f32 v12, v12
    v_exp_f32 v13, v13
    v_pk_fma_f32 v[6:7], v[30:31], v[6:7], v[30:31] op_sel:[1,0,1] op_sel_hi:[1,1,1]
    v_pk_fma_f32 v[8:9], v[30:31], v[8:9], v[30:31] op_sel:[1,0,1] op_sel_hi:[1,1,1]
    v_pk_fma_f32 v[10:11], v[30:31], v[10:11], v[30:31] op_sel:[1,0,1] op_sel_hi:[1,1,1]
    v_pk_fma_f32 v[12:13], v[30:31], v[12:13], v[30:31] op_sel:[1,0,1] op_sel_hi:[1,1,1]
    v_rcp_f32 v6, v6
    v_rcp_f32 v7, v7
    v_rcp_f32 v8, v8
    v_rcp_f32 v9, v9
    v_rcp_f32 v10, v10
    v_rcp_f32 v11, v11
    v_rcp_f32 v12, v12
    v_rcp_f32 v13, v13
    v_pk_mul_f32 v[6:7], v[6:7], v[68:69]
    v_pk_mul_f32 v[8:9], v[8:9], v[70:71]
    v_pk_mul_f32 v[10:11], v[10:11], v[72:73]
    v_pk_mul_f32 v[12:13], v[12:13], v[74:75]
    v_cvt_pk_bf16_f32 v68, v6, v7
    v_cvt_pk_bf16_f32 v69, v8, v9
    v_cvt_pk_bf16_f32 v70, v10, v11
    v_cvt_pk_bf16_f32 v71, v12, v13
    buffer_store_dwordx4 v[68:71], v4, s[64:67], s99 offen offset:2048 sc1
    v_pk_mul_f32 v[6:7], v[76:77], v[76:77]
    v_pk_mul_f32 v[8:9], v[78:79], v[78:79]
    v_pk_mul_f32 v[10:11], v[80:81], v[80:81]
    v_pk_mul_f32 v[12:13], v[82:83], v[82:83]
    v_pk_fma_f32 v[6:7], v[34:35], v[6:7], v[34:35] op_sel:[1,0,0] op_sel_hi:[1,1,0]
    v_pk_fma_f32 v[8:9], v[34:35], v[8:9], v[34:35] op_sel:[1,0,0] op_sel_hi:[1,1,0]
    v_pk_fma_f32 v[10:11], v[34:35], v[10:11], v[34:35] op_sel:[1,0,0] op_sel_hi:[1,1,0]
    v_pk_fma_f32 v[12:13], v[34:35], v[12:13], v[34:35] op_sel:[1,0,0] op_sel_hi:[1,1,0]
    v_pk_mul_f32 v[6:7], v[6:7], v[76:77]
    v_pk_mul_f32 v[8:9], v[8:9], v[78:79]
    v_pk_mul_f32 v[10:11], v[10:11], v[80:81]
    v_pk_mul_f32 v[12:13], v[12:13], v[82:83]
    v_exp_f32 v6, v6
    v_exp_f32 v7, v7
    v_exp_f32 v8, v8
    v_exp_f32 v9, v9
    v_exp_f32 v10, v10
    v_exp_f32 v11, v11
    v_exp_f32 v12, v12
    v_exp_f32 v13, v13
    v_pk_fma_f32 v[6:7], v[30:31], v[6:7], v[30:31] op_sel:[1,0,1] op_sel_hi:[1,1,1]
    v_pk_fma_f32 v[8:9], v[30:31], v[8:9], v[30:31] op_sel:[1,0,1] op_sel_hi:[1,1,1]
    v_pk_fma_f32 v[10:11], v[30:31], v[10:11], v[30:31] op_sel:[1,0,1] op_sel_hi:[1,1,1]
    v_pk_fma_f32 v[12:13], v[30:31], v[12:13], v[30:31] op_sel:[1,0,1] op_sel_hi:[1,1,1]
    v_rcp_f32 v6, v6
    v_rcp_f32 v7, v7
    v_rcp_f32 v8, v8
    v_rcp_f32 v9, v9
    v_rcp_f32 v10, v10
    v_rcp_f32 v11, v11
    v_rcp_f32 v12, v12
    v_rcp_f32 v13, v13
    v_pk_mul_f32 v[6:7], v[6:7], v[76:77]
    v_pk_mul_f32 v[8:9], v[8:9], v[78:79]
    v_pk_mul_f32 v[10:11], v[10:11], v[80:81]
    v_pk_mul_f32 v[12:13], v[12:13], v[82:83]
    v_cvt_pk_bf16_f32 v76, v6, v7
    v_cvt_pk_bf16_f32 v77, v8, v9
    v_cvt_pk_bf16_f32 v78, v10, v11
    v_cvt_pk_bf16_f32 v79, v12, v13
    buffer_store_dwordx4 v[76:79], v4, s[64:67], s99 offen offset:3072 sc1
    ds_read_b32 v12, v0 offset:9536
    ds_read_b64 v[10:11], v85 offset:9216
    s_waitcnt lgkmcnt(0)
    v_cmp_eq_u32_e64 vcc, 0, v12
    s_cbranch_vccnz L_aretry_14
L_aback_15:
    v_fma_f32 v6, v22, v10, v26
    v_fma_f32 v7, v22, v11, v27
    v_fma_f32 v6, -v23, v11, v6
    v_fma_f32 v7, v23, v10, v7
    v_fma_f32 v8, v18, v6, v24
    v_fma_f32 v9, v18, v7, v25
    v_fma_f32 v8, -v19, v7, v8
    v_fma_f32 v9, v19, v6, v9
    v_mul_f32_e64 v26, v20, v6
    v_mul_f32 v27, -v20, v7
    v_fma_f32 v26, -v21, v7, v26
    v_fma_f32 v27, -v21, v6, v27
    v_mul_f32_e64 v24, v20, v8
    v_mul_f32 v25, -v20, v9
    v_fma_f32 v24, -v21, v9, v24
    v_fma_f32 v25, -v21, v8, v25
    v_mov_b32 v6, v26
    v_mov_b32 v7, v24
    v_mov_b32 v8, v27
    v_mov_b32 v9, v25
    v_pk_fma_f32 v[36:37], v[16:17], v[6:7], v[36:37] op_sel_hi:[0,1,1]
    v_pk_fma_f32 v[52:53], v[16:17], v[8:9], v[52:53] op_sel_hi:[0,1,1]
    v_pk_fma_f32 v[36:37], v[16:17], v[8:9], v[36:37] op_sel:[1,0,0] op_sel_hi:[1,1,1]
    v_pk_fma_f32 v[52:53], v[16:17], v[6:7], v[52:53] op_sel:[1,0,0] op_sel_hi:[1,1,1] neg_lo:[1,0,0] neg_hi:[1,0,0]
    v_pk_fma_f32 v[38:39], v[16:17], v[36:37], v[38:39] op_sel_hi:[0,1,1]
    v_pk_fma_f32 v[54:55], v[16:17], v[52:53], v[54:55] op_sel_hi:[0,1,1]
    v_pk_fma_f32 v[38:39], v[16:17], v[52:53], v[38:39] op_sel:[1,0,0] op_sel_hi:[1,1,1]
    v_pk_fma_f32 v[54:55], v[16:17], v[36:37], v[54:55] op_sel:[1,0,0] op_sel_hi:[1,1,1] neg_lo:[1,0,0] neg_hi:[1,0,0]
    v_cvt_pk_bf16_f32 v36, v36, v37
    v_cvt_pk_bf16_f32 v52, v52, v53
    v_pk_fma_f32 v[40:41], v[16:17], v[38:39], v[40:41] op_sel_hi:[0,1,1]
    v_pk_fma_f32 v[56:57], v[16:17], v[54:55], v[56:57] op_sel_hi:[0,1,1]
    v_pk_fma_f32 v[40:41], v[16:17], v[54:55], v[40:41] op_sel:[1,0,0] op_sel_hi:[1,1,1]
    v_pk_fma_f32 v[56:57], v[16:17], v[38:39], v[56:57] op_sel:[1,0,0] op_sel_hi:[1,1,1] neg_lo:[1,0,0] neg_hi:[1,0,0]
    v_cvt_pk_bf16_f32 v37, v38, v39
    v_cvt_pk_bf16_f32 v53, v54, v55
    v_pk_fma_f32 v[42:43], v[16:17], v[40:41], v[42:43] op_sel_hi:[0,1,1]
    v_pk_fma_f32 v[58:59], v[16:17], v[56:57], v[58:59] op_sel_hi:[0,1,1]
    v_pk_fma_f32 v[42:43], v[16:17], v[56:57], v[42:43] op_sel:[1,0,0] op_sel_hi:[1,1,1]
    v_pk_fma_f32 v[58:59], v[16:17], v[40:41], v[58:59] op_sel:[1,0,0] op_sel_hi:[1,1,1] neg_lo:[1,0,0] neg_hi:[1,0,0]
    v_cvt_pk_bf16_f32 v38, v40, v41
    v_cvt_pk_bf16_f32 v54, v56, v57
    v_pk_fma_f32 v[44:45], v[16:17], v[42:43], v[44:45] op_sel_hi:[0,1,1]
    v_pk_fma_f32 v[60:61], v[16:17], v[58:59], v[60:61] op_sel_hi:[0,1,1]
    v_pk_fma_f32 v[44:45], v[16:17], v[58:59], v[44:45] op_sel:[1,0,0] op_sel_hi:[1,1,1]
    v_pk_fma_f32 v[60:61], v[16:17], v[42:43], v[60:61] op_sel:[1,0,0] op_sel_hi:[1,1,1] neg_lo:[1,0,0] neg_hi:[1,0,0]
    v_cvt_pk_bf16_f32 v39, v42, v43
    v_cvt_pk_bf16_f32 v55, v58, v59
    v_pk_fma_f32 v[46:47], v[16:17], v[44:45], v[46:47] op_sel_hi:[0,1,1]
    v_pk_fma_f32 v[62:63], v[16:17], v[60:61], v[62:63] op_sel_hi:[0,1,1]
    v_pk_fma_f32 v[46:47], v[16:17], v[60:61], v[46:47] op_sel:[1,0,0] op_sel_hi:[1,1,1]
    v_pk_fma_f32 v[62:63], v[16:17], v[44:45], v[62:63] op_sel:[1,0,0] op_sel_hi:[1,1,1] neg_lo:[1,0,0] neg_hi:[1,0,0]
    v_cvt_pk_bf16_f32 v40, v44, v45
    v_cvt_pk_bf16_f32 v56, v60, v61
    v_pk_fma_f32 v[48:49], v[16:17], v[46:47], v[48:49] op_sel_hi:[0,1,1]
    v_pk_fma_f32 v[64:65], v[16:17], v[62:63], v[64:65] op_sel_hi:[0,1,1]
    v_pk_fma_f32 v[48:49], v[16:17], v[62:63], v[48:49] op_sel:[1,0,0] op_sel_hi:[1,1,1]
    v_pk_fma_f32 v[64:65], v[16:17], v[46:47], v[64:65] op_sel:[1,0,0] op_sel_hi:[1,1,1] neg_lo:[1,0,0] neg_hi:[1,0,0]
    v_cvt_pk_bf16_f32 v41, v46, v47
    v_cvt_pk_bf16_f32 v57, v62, v63
    v_pk_fma_f32 v[50:51], v[16:17], v[48:49], v[50:51] op_sel_hi:[0,1,1]
    v_pk_fma_f32 v[66:67], v[16:17], v[64:65], v[66:67] op_sel_hi:[0,1,1]
    v_pk_fma_f32 v[50:51], v[16:17], v[64:65], v[50:51] op_sel:[1,0,0] op_sel_hi:[1,1,1]
    v_pk_fma_f32 v[66:67], v[16:17], v[48:49], v[66:67] op_sel:[1,0,0] op_sel_hi:[1,1,1] neg_lo:[1,0,0] neg_hi:[1,0,0]
    v_cvt_pk_bf16_f32 v42, v48, v49
    v_cvt_pk_bf16_f32 v58, v64, v65
    v_cvt_pk_bf16_f32 v43, v50, v51
    v_cvt_pk_bf16_f32 v59, v66, v67
    ds_write_b128 v32, v[36:39] offset:0
    ds_write_b128 v33, v[40:43] offset:0
    ds_read_b64_tr_b16 v[44:45], v86 offset:0
    ds_read_b64_tr_b16 v[46:47], v87 offset:256
    ds_read_b64_tr_b16 v[48:49], v86 offset:1024
    ds_read_b64_tr_b16 v[50:51], v87 offset:1280
    ds_write_b128 v32, v[52:55] offset:0
    ds_write_b128 v33, v[56:59] offset:0
    ds_read_b64_tr_b16 v[60:61], v86 offset:0
    ds_read_b64_tr_b16 v[62:63], v87 offset:256
    ds_read_b64_tr_b16 v[64:65], v86 offset:1024
    ds_read_b64_tr_b16 v[66:67], v87 offset:1280
    s_waitcnt lgkmcnt(8)
    buffer_store_dwordx4 v[44:47], v4, s[64:67], s100 offen offset:0 sc1
    s_waitcnt lgkmcnt(6)
    buffer_store_dwordx4 v[48:51], v4, s[64:67], s100 offen offset:1024 sc1
    s_waitcnt lgkmcnt(2)
    buffer_store_dwordx4 v[60:63], v4, s[64:67], s100 offen offset:2048 sc1
    s_waitcnt lgkmcnt(0)
    buffer_store_dwordx4 v[64:67], v4, s[64:67], s100 offen offset:3072 sc1
    v_mfma_f32_32x32x16_bf16 v[68:83], v[88:91], a[0:3], 0
    ds_read_b64_tr_b16 v[116:117], v15 offset:7168
    ds_read_b64_tr_b16 v[118:119], v15 offset:7424
    v_mfma_f32_32x32x16_bf16 v[68:83], v[92:95], a[4:7], v[68:83]
    ds_read_b64_tr_b16 v[88:89], v15 offset:8192
    ds_read_b64_tr_b16 v[90:91], v15 offset:8448
    v_mfma_f32_32x32x16_bf16 v[68:83], v[96:99], a[8:11], v[68:83]
    ds_read_b64_tr_b16 v[92:93], v15 offset:9216
    ds_read_b64_tr_b16 v[94:95], v15 offset:9472
    v_mfma_f32_32x32x16_bf16 v[68:83], v[100:103], a[12:15], v[68:83]
    ds_read_b64_tr_b16 v[96:97], v15 offset:10240
    ds_read_b64_tr_b16 v[98:99], v15 offset:10496
    s_waitcnt lgkmcnt(6)
    v_mfma_f32_32x32x16_bf16 v[68:83], v[104:107], a[16:19], v[68:83]
    ds_read_b64_tr_b16 v[100:101], v15 offset:11264
    ds_read_b64_tr_b16 v[102:103], v15 offset:11520
    v_mfma_f32_32x32x16_bf16 v[68:83], v[108:111], a[20:23], v[68:83]
    ds_read_b64_tr_b16 v[104:105], v15 offset:12288
    ds_read_b64_tr_b16 v[106:107], v15 offset:12544
    v_mfma_f32_32x32x16_bf16 v[68:83], v[112:115], a[24:27], v[68:83]
    ds_read_b64_tr_b16 v[108:109], v15 offset:13312
    ds_read_b64_tr_b16 v[110:111], v15 offset:13568
    v_mfma_f32_32x32x16_bf16 v[68:83], v[116:119], a[28:31], v[68:83]
    ds_read_b64_tr_b16 v[112:113], v15 offset:14336
    ds_read_b64_tr_b16 v[114:115], v15 offset:14592
    s_waitcnt lgkmcnt(6)
    v_mfma_f32_32x32x16_bf16 v[68:83], v[88:91], a[32:35], v[68:83]
    ds_read_b64_tr_b16 v[116:117], v15 offset:15360
    ds_read_b64_tr_b16 v[118:119], v15 offset:15616
    v_mfma_f32_32x32x16_bf16 v[68:83], v[92:95], a[36:39], v[68:83]
    ds_read_b64_tr_b16 v[88:89], v15 offset:16384
    ds_read_b64_tr_b16 v[90:91], v15 offset:16640
    v_mfma_f32_32x32x16_bf16 v[68:83], v[96:99], a[40:43], v[68:83]
    ds_read_b64_tr_b16 v[92:93], v15 offset:17408
    ds_read_b64_tr_b16 v[94:95], v15 offset:17664
    v_mfma_f32_32x32x16_bf16 v[68:83], v[100:103], a[44:47], v[68:83]
    ds_read_b64_tr_b16 v[96:97], v15 offset:18432
    ds_read_b64_tr_b16 v[98:99], v15 offset:18688
    s_waitcnt lgkmcnt(6)
    v_mfma_f32_32x32x16_bf16 v[68:83], v[104:107], a[48:51], v[68:83]
    ds_read_b64_tr_b16 v[100:101], v15 offset:19456
    ds_read_b64_tr_b16 v[102:103], v15 offset:19712
    v_mfma_f32_32x32x16_bf16 v[68:83], v[108:111], a[52:55], v[68:83]
    ds_read_b64_tr_b16 v[104:105], v15 offset:20480
    ds_read_b64_tr_b16 v[106:107], v15 offset:20736
    v_mfma_f32_32x32x16_bf16 v[68:83], v[112:115], a[56:59], v[68:83]
    ds_read_b64_tr_b16 v[108:109], v15 offset:21504
    ds_read_b64_tr_b16 v[110:111], v15 offset:21760
    v_mfma_f32_32x32x16_bf16 v[68:83], v[116:119], a[60:63], v[68:83]
    ds_read_b64_tr_b16 v[112:113], v15 offset:22528
    ds_read_b64_tr_b16 v[114:115], v15 offset:22784
    s_waitcnt lgkmcnt(6)
    v_mfma_f32_32x32x16_bf16 v[68:83], v[88:91], a[64:67], v[68:83]
    ds_read_b64_tr_b16 v[116:117], v15 offset:23552
    ds_read_b64_tr_b16 v[118:119], v15 offset:23808
    v_mfma_f32_32x32x16_bf16 v[68:83], v[92:95], a[68:71], v[68:83]
    ds_read_b64_tr_b16 v[88:89], v15 offset:24576
    ds_read_b64_tr_b16 v[90:91], v15 offset:24832
    v_mfma_f32_32x32x16_bf16 v[68:83], v[96:99], a[72:75], v[68:83]
    ds_read_b64_tr_b16 v[92:93], v15 offset:25600
    ds_read_b64_tr_b16 v[94:95], v15 offset:25856
    v_mfma_f32_32x32x16_bf16 v[68:83], v[100:103], a[76:79], v[68:83]
    ds_read_b64_tr_b16 v[96:97], v15 offset:26624
    ds_read_b64_tr_b16 v[98:99], v15 offset:26880
    s_waitcnt vmcnt(4)
    s_add_u32 s1, s101, 8192
    v_mov_b32_e64 v84, s8
    s_mov_b64 exec, 1
    buffer_store_dword v84, v0, s[64:67], s1 offen sc1
    s_mov_b64 exec, -1
    s_waitcnt lgkmcnt(6)
    v_mfma_f32_32x32x16_bf16 v[68:83], v[104:107], a[80:83], v[68:83]
    ds_read_b64_tr_b16 v[100:101], v15 offset:27648
    ds_read_b64_tr_b16 v[102:103], v15 offset:27904
    v_mfma_f32_32x32x16_bf16 v[68:83], v[108:111], a[84:87], v[68:83]
    ds_read_b64_tr_b16 v[104:105], v15 offset:28672
    ds_read_b64_tr_b16 v[106:107], v15 offset:28928
    v_mfma_f32_32x32x16_bf16 v[68:83], v[112:115], a[88:91], v[68:83]
    ds_read_b64_tr_b16 v[108:109], v15 offset:29696
    ds_read_b64_tr_b16 v[110:111], v15 offset:29952
    v_mfma_f32_32x32x16_bf16 v[68:83], v[116:119], a[92:95], v[68:83]
    ds_read_b64_tr_b16 v[112:113], v15 offset:30720
    ds_read_b64_tr_b16 v[114:115], v15 offset:30976
    s_waitcnt lgkmcnt(6)
    v_mfma_f32_32x32x16_bf16 v[68:83], v[88:91], a[96:99], v[68:83]
    ds_read_b64_tr_b16 v[116:117], v15 offset:31744
    ds_read_b64_tr_b16 v[118:119], v15 offset:32000
    v_mfma_f32_32x32x16_bf16 v[68:83], v[92:95], a[100:103], v[68:83]
    v_mfma_f32_32x32x16_bf16 v[68:83], v[96:99], a[104:107], v[68:83]
    v_mfma_f32_32x32x16_bf16 v[68:83], v[100:103], a[108:111], v[68:83]
    s_waitcnt lgkmcnt(0)
    v_mfma_f32_32x32x16_bf16 v[68:83], v[104:107], a[112:115], v[68:83]
    v_mfma_f32_32x32x16_bf16 v[68:83], v[108:111], a[116:119], v[68:83]
    v_mfma_f32_32x32x16_bf16 v[68:83], v[112:115], a[120:123], v[68:83]
    v_mfma_f32_32x32x16_bf16 v[68:83], v[116:119], a[124:127], v[68:83]
    v_mov_b32_e64 v84, 11
    ds_write_b32 v127, v84 offset:9488
    s_cmp_ge_u32 s5, 11
    s_cbranch_scc1 L_askip5_16
    v_mov_b32 v10, v126
    v_mov_b32 v11, v30
    v_mov_b32 v12, 0
    v_mov_b32 v13, 0
    s_nop 1
    v_mfma_f32_32x32x16_bf16 v[68:83], v[10:13], v[120:123], v[68:83]
    s_nop 11
    v_pk_mul_f32 v[6:7], v[68:69], v[68:69]
    v_pk_mul_f32 v[8:9], v[70:71], v[70:71]
    v_pk_mul_f32 v[10:11], v[72:73], v[72:73]
    v_pk_mul_f32 v[12:13], v[74:75], v[74:75]
    v_pk_fma_f32 v[6:7], v[34:35], v[6:7], v[34:35] op_sel:[1,0,0] op_sel_hi:[1,1,0]
    v_pk_fma_f32 v[8:9], v[34:35], v[8:9], v[34:35] op_sel:[1,0,0] op_sel_hi:[1,1,0]
    v_pk_fma_f32 v[10:11], v[34:35], v[10:11], v[34:35] op_sel:[1,0,0] op_sel_hi:[1,1,0]
    v_pk_fma_f32 v[12:13], v[34:35], v[12:13], v[34:35] op_sel:[1,0,0] op_sel_hi:[1,1,0]
    v_pk_mul_f32 v[6:7], v[6:7], v[68:69]
    v_pk_mul_f32 v[8:9], v[8:9], v[70:71]
    v_pk_mul_f32 v[10:11], v[10:11], v[72:73]
    v_pk_mul_f32 v[12:13], v[12:13], v[74:75]
    v_exp_f32 v6, v6
    v_exp_f32 v7, v7
    v_exp_f32 v8, v8
    v_exp_f32 v9, v9
    v_exp_f32 v10, v10
    v_exp_f32 v11, v11
    v_exp_f32 v12, v12
    v_exp_f32 v13, v13
    v_pk_fma_f32 v[6:7], v[30:31], v[6:7], v[30:31] op_sel:[1,0,1] op_sel_hi:[1,1,1]
    v_pk_fma_f32 v[8:9], v[30:31], v[8:9], v[30:31] op_sel:[1,0,1] op_sel_hi:[1,1,1]
    v_pk_fma_f32 v[10:11], v[30:31], v[10:11], v[30:31] op_sel:[1,0,1] op_sel_hi:[1,1,1]
    v_pk_fma_f32 v[12:13], v[30:31], v[12:13], v[30:31] op_sel:[1,0,1] op_sel_hi:[1,1,1]
    v_rcp_f32 v6, v6
    v_rcp_f32 v7, v7
    v_rcp_f32 v8, v8
    v_rcp_f32 v9, v9
    v_rcp_f32 v10, v10
    v_rcp_f32 v11, v11
    v_rcp_f32 v12, v12
    v_rcp_f32 v13, v13
    v_pk_mul_f32 v[6:7], v[6:7], v[68:69]
    v_pk_mul_f32 v[8:9], v[8:9], v[70:71]
    v_pk_mul_f32 v[10:11], v[10:11], v[72:73]
    v_pk_mul_f32 v[12:13], v[12:13], v[74:75]
    v_cvt_pk_bf16_f32 v68, v6, v7
    v_cvt_pk_bf16_f32 v69, v8, v9
    v_cvt_pk_bf16_f32 v70, v10, v11
    v_cvt_pk_bf16_f32 v71, v12, v13
    buffer_store_dwordx4 v[68:71], v4, s[64:67], s97 offen offset:0 sc1
    v_pk_mul_f32 v[6:7], v[76:77], v[76:77]
    v_pk_mul_f32 v[8:9], v[78:79], v[78:79]
    v_pk_mul_f32 v[10:11], v[80:81], v[80:81]
    v_pk_mul_f32 v[12:13], v[82:83], v[82:83]
    v_pk_fma_f32 v[6:7], v[34:35], v[6:7], v[34:35] op_sel:[1,0,0] op_sel_hi:[1,1,0]
    v_pk_fma_f32 v[8:9], v[34:35], v[8:9], v[34:35] op_sel:[1,0,0] op_sel_hi:[1,1,0]
    v_pk_fma_f32 v[10:11], v[34:35], v[10:11], v[34:35] op_sel:[1,0,0] op_sel_hi:[1,1,0]
    v_pk_fma_f32 v[12:13], v[34:35], v[12:13], v[34:35] op_sel:[1,0,0] op_sel_hi:[1,1,0]
    v_pk_mul_f32 v[6:7], v[6:7], v[76:77]
    v_pk_mul_f32 v[8:9], v[8:9], v[78:79]
    v_pk_mul_f32 v[10:11], v[10:11], v[80:81]
    v_pk_mul_f32 v[12:13], v[12:13], v[82:83]
    v_exp_f32 v6, v6
    v_exp_f32 v7, v7
    v_exp_f32 v8, v8
    v_exp_f32 v9, v9
    v_exp_f32 v10, v10
    v_exp_f32 v11, v11
    v_exp_f32 v12, v12
    v_exp_f32 v13, v13
    v_pk_fma_f32 v[6:7], v[30:31], v[6:7], v[30:31] op_sel:[1,0,1] op_sel_hi:[1,1,1]
    v_pk_fma_f32 v[8:9], v[30:31], v[8:9], v[30:31] op_sel:[1,0,1] op_sel_hi:[1,1,1]
    v_pk_fma_f32 v[10:11], v[30:31], v[10:11], v[30:31] op_sel:[1,0,1] op_sel_hi:[1,1,1]
    v_pk_fma_f32 v[12:13], v[30:31], v[12:13], v[30:31] op_sel:[1,0,1] op_sel_hi:[1,1,1]
    v_rcp_f32 v6, v6
    v_rcp_f32 v7, v7
    v_rcp_f32 v8, v8
    v_rcp_f32 v9, v9
    v_rcp_f32 v10, v10
    v_rcp_f32 v11, v11
    v_rcp_f32 v12, v12
    v_rcp_f32 v13, v13
    v_pk_mul_f32 v[6:7], v[6:7], v[76:77]
    v_pk_mul_f32 v[8:9], v[8:9], v[78:79]
    v_pk_mul_f32 v[10:11], v[10:11], v[80:81]
    v_pk_mul_f32 v[12:13], v[12:13], v[82:83]
    v_cvt_pk_bf16_f32 v76, v6, v7
    v_cvt_pk_bf16_f32 v77, v8, v9
    v_cvt_pk_bf16_f32 v78, v10, v11
    v_cvt_pk_bf16_f32 v79, v12, v13
    buffer_store_dwordx4 v[76:79], v4, s[64:67], s97 offen offset:1024 sc1
    s_waitcnt vmcnt(3)
    s_add_u32 s1, s101, 16384
    v_mov_b32_e64 v84, s8
    s_mov_b64 exec, 1
    buffer_store_dword v84, v0, s[64:67], s1 offen sc1
    s_mov_b64 exec, -1
    s_waitcnt vmcnt(1)
    s_add_u32 s1, s101, 24576
    v_mov_b32 v84, s8
    s_mov_b64 exec, 1
    buffer_store_dword v84, v0, s[64:67], s1 offen sc1
    s_mov_b64 exec, -1
    s_branch L_afin_17
L_askip5_16:
    s_waitcnt vmcnt(1)
    s_add_u32 s1, s101, 16384
    v_mov_b32 v84, s8
    s_mov_b64 exec, 1
    buffer_store_dword v84, v0, s[64:67], s1 offen sc1
    s_mov_b64 exec, -1
    s_add_u32 s1, s101, 24576
    v_mov_b32_e64 v84, s8
    s_mov_b64 exec, 1
    buffer_store_dword v84, v0, s[64:67], s1 offen sc1
    s_mov_b64 exec, -1
L_afin_17:
    s_setprio 0
    s_mov_b32 s84, s46
    s_and_b32 s85, s47, 0xffff
    s_mov_b32 s86, 0x400000
    s_mov_b32 s87, 0x20000
    s_lshr_b32 s12, s5, 3
    s_and_b32 s13, s5, 7
    s_lshl_b32 s10, s4, 1
    s_add_u32 s7, s10, s12
    v_bfe_u32 v110, v1, 4, 1
    v_lshlrev_b32 v110, 3, v110
    v_add_u32 v110, v110, v3
    s_lshl_b32 s10, s3, 1
    s_lshl_b32 s11, s7, 6
    s_add_u32 s10, s10, s11
    v_add_u32 v110, s10, v110
    v_add_u32 v104, 0, v110
    v_add_u32 v105, 16, v110
    v_add_u32 v106, 32, v110
    v_add_u32 v107, 48, v110
    v_and_b32 v108, 15, v1
    v_lshlrev_b32 v108, 3, v108
    s_lshl_b32 s10, s13, 7
    v_add_u32 v108, s10, v108
    global_load_dwordx2 v[100:101], v108, s[32:33]
    global_load_dwordx2 v[102:103], v108, s[42:43]
    v_lshl_add_u32 v112, v104, 10, v108
    buffer_load_dwordx2 v[88:89], v112, s[52:55], 0 offen
    v_lshl_add_u32 v113, v105, 10, v108
    buffer_load_dwordx2 v[90:91], v113, s[52:55], 0 offen
    v_lshl_add_u32 v114, v106, 10, v108
    buffer_load_dwordx2 v[92:93], v114, s[52:55], 0 offen
    v_lshl_add_u32 v115, v107, 10, v108
    buffer_load_dwordx2 v[94:95], v115, s[52:55], 0 offen
    s_lshl_b32 s10, s12, 3
    s_add_u32 s10, s10, s3
    s_lshl_b32 s10, s10, 6
    v_lshrrev_b32 v8, 4, v1
    v_lshl_add_u32 v9, v8, 3, s10
    ds_read_b32 v96, v9 offset:8196
    ds_read_b32 v97, v9 offset:8228
    ds_read_b32 v98, v9 offset:8452
    ds_read_b32 v99, v9 offset:8484
    v_and_b32 v10, 15, v1
    v_xor_b32 v10, v10, v8
    v_lshlrev_b32 v10, 4, v10
    v_lshl_add_u32 v8, v8, 8, v10
    s_lshl_b32 s10, s3, 11
    s_add_u32 s10, s10, 65536
    v_add_u32 v8, s10, v8
    v_xor_b32 v9, 64, v8
    v_lshlrev_b32_e64 v104, 11, v104
    v_lshl_add_u32 v104, v108, 1, v104
    v_lshlrev_b32_e64 v105, 11, v105
    v_lshl_add_u32 v105, v108, 1, v105
    v_lshlrev_b32_e64 v106, 11, v106
    v_lshl_add_u32 v106, v108, 1, v106
    v_lshlrev_b32_e64 v107, 11, v107
    v_lshl_add_u32 v107, v108, 1, v107
    s_waitcnt vmcnt(0) lgkmcnt(0)
    v_lshlrev_b32 v112, 16, v100
    v_and_b32 v113, 0xffff0000, v100
    v_lshlrev_b32_e64 v116, 16, v102
    v_and_b32 v117, 0xffff0000, v102
    v_lshlrev_b32_e64 v114, 16, v101
    v_and_b32 v115, 0xffff0000, v101
    v_lshlrev_b32_e64 v118, 16, v103
    v_and_b32 v119, 0xffff0000, v103
    v_lshlrev_b32_e64 v68, 16, v88
    v_and_b32 v69, 0xffff0000, v88
    v_lshlrev_b32_e64 v70, 16, v89
    v_and_b32 v71, 0xffff0000, v89
    v_pk_mul_f32 v[68:69], v[68:69], v[112:113]
    v_pk_mul_f32 v[70:71], v[70:71], v[114:115]
    v_cvt_pk_bf16_f32 v88, v68, v69
    v_cvt_pk_bf16_f32 v89, v70, v71
    v_lshlrev_b32_e64 v6, 16, v96
    v_and_b32 v7, 0xffff0000, v96
    v_lshlrev_b32_e64 v68, 16, v88
    v_and_b32 v69, 0xffff0000, v88
    v_lshlrev_b32_e64 v70, 16, v89
    v_and_b32 v71, 0xffff0000, v89
    v_max_f32 v96, 0x21800000, v6
    v_pk_mul_f32 v[68:69], v[68:69], v[6:7] op_sel_hi:[1,0]
    v_pk_mul_f32 v[70:71], v[70:71], v[6:7] op_sel_hi:[1,0]
    v_pk_fma_f32 v[68:69], v[6:7], v[116:117], v[68:69] op_sel:[1,0,0] op_sel_hi:[1,1,1]
    v_pk_fma_f32 v[70:71], v[6:7], v[118:119], v[70:71] op_sel:[1,0,0] op_sel_hi:[1,1,1]
    v_lshlrev_b32_e64 v72, 16, v90
    v_and_b32 v73, 0xffff0000, v90
    v_lshlrev_b32_e64 v74, 16, v91
    v_and_b32 v75, 0xffff0000, v91
    v_pk_mul_f32 v[72:73], v[72:73], v[112:113]
    v_pk_mul_f32 v[74:75], v[74:75], v[114:115]
    v_cvt_pk_bf16_f32 v90, v72, v73
    v_cvt_pk_bf16_f32 v91, v74, v75
    v_lshlrev_b32_e64 v6, 16, v97
    v_and_b32 v7, 0xffff0000, v97
    v_lshlrev_b32_e64 v72, 16, v90
    v_and_b32 v73, 0xffff0000, v90
    v_lshlrev_b32_e64 v74, 16, v91
    v_and_b32 v75, 0xffff0000, v91
    v_max_f32 v97, 0x21800000, v6
    v_pk_mul_f32 v[72:73], v[72:73], v[6:7] op_sel_hi:[1,0]
    v_pk_mul_f32 v[74:75], v[74:75], v[6:7] op_sel_hi:[1,0]
    v_pk_fma_f32 v[72:73], v[6:7], v[116:117], v[72:73] op_sel:[1,0,0] op_sel_hi:[1,1,1]
    v_pk_fma_f32 v[74:75], v[6:7], v[118:119], v[74:75] op_sel:[1,0,0] op_sel_hi:[1,1,1]
    v_lshlrev_b32_e64 v76, 16, v92
    v_and_b32 v77, 0xffff0000, v92
    v_lshlrev_b32_e64 v78, 16, v93
    v_and_b32 v79, 0xffff0000, v93
    v_pk_mul_f32 v[76:77], v[76:77], v[112:113]
    v_pk_mul_f32 v[78:79], v[78:79], v[114:115]
    v_cvt_pk_bf16_f32 v92, v76, v77
    v_cvt_pk_bf16_f32 v93, v78, v79
    v_lshlrev_b32_e64 v6, 16, v98
    v_and_b32 v7, 0xffff0000, v98
    v_lshlrev_b32_e64 v76, 16, v92
    v_and_b32 v77, 0xffff0000, v92
    v_lshlrev_b32_e64 v78, 16, v93
    v_and_b32 v79, 0xffff0000, v93
    v_max_f32 v98, 0x21800000, v6
    v_pk_mul_f32 v[76:77], v[76:77], v[6:7] op_sel_hi:[1,0]
    v_pk_mul_f32 v[78:79], v[78:79], v[6:7] op_sel_hi:[1,0]
    v_pk_fma_f32 v[76:77], v[6:7], v[116:117], v[76:77] op_sel:[1,0,0] op_sel_hi:[1,1,1]
    v_pk_fma_f32 v[78:79], v[6:7], v[118:119], v[78:79] op_sel:[1,0,0] op_sel_hi:[1,1,1]
    v_lshlrev_b32_e64 v80, 16, v94
    v_and_b32 v81, 0xffff0000, v94
    v_lshlrev_b32_e64 v82, 16, v95
    v_and_b32 v83, 0xffff0000, v95
    v_pk_mul_f32 v[80:81], v[80:81], v[112:113]
    v_pk_mul_f32 v[82:83], v[82:83], v[114:115]
    v_cvt_pk_bf16_f32 v94, v80, v81
    v_cvt_pk_bf16_f32 v95, v82, v83
    v_lshlrev_b32_e64 v6, 16, v99
    v_and_b32 v7, 0xffff0000, v99
    v_lshlrev_b32_e64 v80, 16, v94
    v_and_b32 v81, 0xffff0000, v94
    v_lshlrev_b32_e64 v82, 16, v95
    v_and_b32 v83, 0xffff0000, v95
    v_max_f32 v99, 0x21800000, v6
    v_pk_mul_f32 v[80:81], v[80:81], v[6:7] op_sel_hi:[1,0]
    v_pk_mul_f32 v[82:83], v[82:83], v[6:7] op_sel_hi:[1,0]
    v_pk_fma_f32 v[80:81], v[6:7], v[116:117], v[80:81] op_sel:[1,0,0] op_sel_hi:[1,1,1]
    v_pk_fma_f32 v[82:83], v[6:7], v[118:119], v[82:83] op_sel:[1,0,0] op_sel_hi:[1,1,1]
    s_waitcnt lgkmcnt(0)
    s_barrier
    ds_read_b128 v[36:39], v8 offset:0
    ds_read_b128 v[40:43], v8 offset:8192
    ds_read_b128 v[44:47], v8 offset:16384
    ds_read_b128 v[48:51], v8 offset:24576
    ds_read_b128 v[52:55], v9 offset:1024
    ds_read_b128 v[56:59], v9 offset:9216
    ds_read_b128 v[60:63], v9 offset:17408
    ds_read_b128 v[64:67], v9 offset:25600
    s_waitcnt lgkmcnt(4)
    v_pk_add_f32 v[36:37], v[36:37], v[40:41]
    v_pk_add_f32 v[38:39], v[38:39], v[42:43]
    v_pk_add_f32 v[44:45], v[44:45], v[48:49]
    v_pk_add_f32 v[46:47], v[46:47], v[50:51]
    v_pk_add_f32 v[36:37], v[36:37], v[44:45]
    v_pk_add_f32 v[38:39], v[38:39], v[46:47]
    v_pk_fma_f32 v[68:69], v[96:97], v[36:37], v[68:69] op_sel:[0,0,0] op_sel_hi:[0,1,1]
    v_pk_fma_f32 v[70:71], v[96:97], v[38:39], v[70:71] op_sel:[0,0,0] op_sel_hi:[0,1,1]
    buffer_store_dwordx4 v[68:71], v104, s[84:87], 0 offen sc1
    s_waitcnt lgkmcnt(0)
    v_pk_add_f32 v[52:53], v[52:53], v[56:57]
    v_pk_add_f32 v[54:55], v[54:55], v[58:59]
    v_pk_add_f32 v[60:61], v[60:61], v[64:65]
    v_pk_add_f32 v[62:63], v[62:63], v[66:67]
    v_pk_add_f32 v[52:53], v[52:53], v[60:61]
    v_pk_add_f32 v[54:55], v[54:55], v[62:63]
    v_pk_fma_f32 v[72:73], v[96:97], v[52:53], v[72:73] op_sel:[1,0,0] op_sel_hi:[1,1,1]
    v_pk_fma_f32 v[74:75], v[96:97], v[54:55], v[74:75] op_sel:[1,0,0] op_sel_hi:[1,1,1]
    buffer_store_dwordx4 v[72:75], v105, s[84:87], 0 offen sc1
    s_barrier
    ds_read_b128 v[36:39], v8 offset:32768
    ds_read_b128 v[40:43], v8 offset:40960
    ds_read_b128 v[44:47], v8 offset:49152
    ds_read_b128 v[48:51], v8 offset:57344
    ds_read_b128 v[52:55], v9 offset:33792
    ds_read_b128 v[56:59], v9 offset:41984
    ds_read_b128 v[60:63], v9 offset:50176
    ds_read_b128 v[64:67], v9 offset:58368
    s_waitcnt lgkmcnt(4)
    v_pk_add_f32 v[36:37], v[36:37], v[40:41]
    v_pk_add_f32 v[38:39], v[38:39], v[42:43]
    v_pk_add_f32 v[44:45], v[44:45], v[48:49]
    v_pk_add_f32 v[46:47], v[46:47], v[50:51]
    v_pk_add_f32 v[36:37], v[36:37], v[44:45]
    v_pk_add_f32 v[38:39], v[38:39], v[46:47]
    v_pk_fma_f32 v[76:77], v[98:99], v[36:37], v[76:77] op_sel:[0,0,0] op_sel_hi:[0,1,1]
    v_pk_fma_f32 v[78:79], v[98:99], v[38:39], v[78:79] op_sel:[0,0,0] op_sel_hi:[0,1,1]
    buffer_store_dwordx4 v[76:79], v106, s[84:87], 0 offen sc1
    s_waitcnt lgkmcnt(0)
    v_pk_add_f32 v[52:53], v[52:53], v[56:57]
    v_pk_add_f32 v[54:55], v[54:55], v[58:59]
    v_pk_add_f32 v[60:61], v[60:61], v[64:65]
    v_pk_add_f32 v[62:63], v[62:63], v[66:67]
    v_pk_add_f32 v[52:53], v[52:53], v[60:61]
    v_pk_add_f32 v[54:55], v[54:55], v[62:63]
    v_pk_fma_f32 v[80:81], v[98:99], v[52:53], v[80:81] op_sel:[1,0,0] op_sel_hi:[1,1,1]
    v_pk_fma_f32 v[82:83], v[98:99], v[54:55], v[82:83] op_sel:[1,0,0] op_sel_hi:[1,1,1]
    buffer_store_dwordx4 v[80:83], v107, s[84:87], 0 offen sc1
    s_or_b32 s10, s3, s5
    s_cmp_lg_u32 s10, 0
    s_cbranch_scc1 L_an1_18
    s_mov_b64 exec, 1
    s_lshl_b32 s10, s4, 7
    s_add_u32 s10, s10, 0xb00000
    v_mov_b32_e64 v6, s8
    buffer_store_dword v6, v0, s[64:67], s10 offen
    s_mov_b64 exec, -1
L_an1_18:
    s_endpgm
L_roleB:
    v_lshrrev_b32 v32, 3, v1
    v_and_b32 v33, 7, v1
    v_lshrrev_b32 v34, 1, v32
    v_xor_b32 v33, v33, v34
    v_lshlrev_b32_e64 v33, 4, v33
    v_lshl_add_u32 v20, v32, 10, v33
    v_xor_b32_e64 v21, 64, v20
    v_add_u32 v21, 7168, v21
    v_lshrrev_b32 v34, 2, v32
    v_lshlrev_b32 v34, 4, v34
    v_and_b32_e64 v35, 1, v32
    v_lshl_add_u32 v34, v35, 3, v34
    v_bfe_u32 v35, v32, 1, 1
    v_add_u32 v34, v34, v35
    s_lshl_b32 s10, s3, 5
    v_add_u32_e64 v34, s10, v34
    v_lshl_add_u32 v16, v34, 10, v33
    v_xor_b32_e64 v17, 64, v16
    v_add_u32 v17, 1024, v17
    v_add_u32 v18, 2048, v16
    v_add_u32 v19, 2048, v17
    s_lshl_b32 s88, s4, 17
    s_lshl_b32 s10, s5, 5
    s_and_b32 s11, s3, 1
    s_lshl_b32 s12, s11, 4
    s_add_u32 s10, s10, s12
    s_lshl_b32 s89, s10, 10
    s_mul_i32 s10, s11, 88064
    s_lshl_b32 s11, s6, 5
    s_add_u32 s90, s10, s11
    v_lshrrev_b32_e64 v32, 2, v1
    v_mul_u32_u24 v32, 2752, v32
    v_and_b32_e64 v33, 3, v1
    v_lshl_add_u32 v24, v33, 4, v32
    v_add_u32 v25, 43008, v24
    s_lshl_b32 s10, s5, 6
    v_lshl_add_u32 v39, v2, 1, s10
    s_waitcnt lgkmcnt(0)
    s_mov_b32 s98, 0
    s_mov_b32 s52, s16
    s_and_b32 s53, s17, 0xffff
    s_mov_b32 s54, 0x200000
    s_mov_b32 s55, 0x20000
    s_cmp_lt_u32 s3, 2
    s_cselect_b32 s56, s22, s24
    s_cselect_b32 s10, s23, s25
    s_and_b32 s57, s10, 0xffff
    s_mov_b32 s58, 0x80000
    s_mov_b32 s59, 0x20000
    s_add_u32 s0, s95, 0
    s_and_b32 s0, s0, 7
    s_lshl_b32 s0, s0, 7
    s_add_u32 m0, s91, 0
    s_add_u32 s1, s0, s88
    buffer_load_dwordx4 v16, s[52:55], s1 offen offset:0  lds
    buffer_load_dwordx4 v17, s[52:55], s1 offen offset:1024  lds
    buffer_load_dwordx4 v18, s[52:55], s1 offen offset:2048  lds
    buffer_load_dwordx4 v19, s[52:55], s1 offen offset:3072  lds
    s_add_u32 m0, s92, 16384
    s_add_u32 s1, s0, s89
    buffer_load_dwordx4 v20, s[56:59], s1 offen offset:0  lds
    buffer_load_dwordx4 v21, s[56:59], s1 offen offset:1024  lds
    s_lshl_b32 s10, s4, 7
    s_add_u32 s10, s10, 0xb00000
    s_load_dword s8, s[50:51], s10
    s_lshl_b32 s11, s5, 7
    s_add_u32 s11, s11, 0xb00800
    s_load_dword s9, s[50:51], s11
    s_mov_b32 s60, s36
    s_and_b32 s61, s37, 0xffff
    s_mov_b32 s62, 0x158000
    s_mov_b32 s63, 0x20000
    s_mov_b32 s64, s50
    s_and_b32 s65, s51, 0xffff
    s_mov_b32 s66, 0xc00000
    s_mov_b32 s67, 0x20000
    s_mov_b32 s72, s26
    s_and_b32 s73, s27, 0xffff
    s_mov_b32 s74, 0x80000
    s_mov_b32 s75, 0x20000
    s_mov_b32 s80, s40
    s_and_b32 s81, s41, 0xffff
    s_mov_b32 s82, 0x158000
    s_mov_b32 s83, 0x20000
    s_lshl_b32 s10, s3, 12
    s_add_u32 s34, s10, 16384
    s_mul_i32 s10, s3, 8192
    s_add_u32 s93, s10, 65536
    s_lshr_b32 s11, s5, 3
    s_and_b32 s97, s5, 7
    s_lshl_b32 s10, s97, 16
    s_lshl_b32 s11, s3, 8
    s_add_u32 s35, s10, s11
    s_add_u32 s94, s2, s97
    s_and_b32 s94, s94, 3
    s_add_u32 s11, s94, 0
    s_and_b32 s11, s11, 3
    s_lshl_b32 s10, s3, 2
    s_add_u32 s10, s10, s11
    s_min_u32 s11, s10, 11
    s_lshl_b32 s11, s11, 1
    s_lshl_b32 s10, s10, 2
    s_add_u32 s68, s10, s11
    s_add_u32 s11, s94, 1
    s_and_b32 s11, s11, 3
    s_lshl_b32 s10, s3, 2
    s_add_u32 s10, s10, s11
    s_min_u32 s11, s10, 11
    s_lshl_b32 s11, s11, 1
    s_lshl_b32 s10, s10, 2
    s_add_u32 s69, s10, s11
    s_add_u32 s11, s94, 2
    s_and_b32 s11, s11, 3
    s_lshl_b32 s10, s3, 2
    s_add_u32 s10, s10, s11
    s_min_u32 s11, s10, 11
    s_lshl_b32 s11, s11, 1
    s_lshl_b32 s10, s10, 2
    s_add_u32 s70, s10, s11
    s_add_u32 s11, s94, 3
    s_and_b32 s11, s11, 3
    s_lshl_b32 s10, s3, 2
    s_add_u32 s10, s10, s11
    s_min_u32 s11, s10, 11
    s_lshl_b32 s11, s11, 1
    s_lshl_b32 s10, s10, 2
    s_add_u32 s71, s10, s11
    s_mul_i32 s96, s3, 18
    s_add_u32 s96, s96, 4
    s_add_u32 s7, s96, 12
    s_min_u32 s7, s7, 64
    v_bfe_u32 v32, v1, 1, 2
    s_lshl_b32 s10, s3, 2
    v_add_u32 v33, s10, v32
    v_lshlrev_b32 v15, 9, v33
    v_and_b32_e64 v34, 1, v1
    v_lshl_add_u32 v15, v34, 7, v15
    s_mul_i32 s10, s3, 3
    v_min_u32 v32, 2, v32
    v_add_u32 v32, s10, v32
    v_min_u32 v32, 10, v32
    v_lshlrev_b32_e64 v32, 9, v32
    v_lshl_add_u32 v9, v34, 7, v32
    v_and_b32_e64 v32, 8, v1
    v_cmp_eq_u32 vcc, 0, v32
    s_nop 1
    v_cndmask_b32 v9, v9, v15, vcc
    s_lshr_b32 s11, s5, 3
    s_and_b32 s12, s5, 7
    s_lshl_b32 s10, s4, 1
    s_add_u32 s12, s10, s11
    s_mul_i32 s84, s12, 307200
    s_lshl_b32 s10, s4, 15
    s_lshl_b32 s11, s11, 8
    s_add_u32 s10, s10, s11
    s_add_u32 s85, s10, 0xa80000
    v_add_u32 v22, 14336, v20
    v_add_u32 v23, 14336, v21
    v_lshrrev_b32 v32, 3, v1
    v_and_b32 v33, 7, v1
    v_bfe_u32 v34, v1, 4, 1
    v_lshlrev_b32 v34, 2, v34
    v_xor_b32 v33, v33, v34
    v_lshlrev_b32_e64 v33, 4, v33
    v_lshl_add_u32 v26, v32, 10, v33
    v_add_u32 v27, 7168, v26
    v_lshrrev_b32 v32, 1, v2
    v_and_b32 v32, 7, v32
    v_xor_b32 v32, v32, v3
    v_lshlrev_b32 v32, 4, v32
    v_lshl_add_u32 v32, v2, 7, v32
    v_add_u32 v112, s34, v32
    v_xor_b32 v113, 32, v112
    v_xor_b32_e64 v114, 64, v112
    v_xor_b32 v115, 96, v112
    v_bfe_u32 v32, v1, 2, 2
    v_lshl_add_u32 v32, v3, 2, v32
    v_bfe_u32 v33, v1, 4, 1
    v_bfe_u32 v34, v1, 1, 1
    v_lshl_add_u32 v33, v33, 1, v34
    v_bfe_u32 v34, v1, 3, 1
    v_lshl_add_u32 v33, v34, 2, v33
    v_lshlrev_b32 v33, 4, v33
    v_and_b32 v34, 1, v1
    v_lshl_add_u32 v33, v34, 3, v33
    v_lshl_add_u32 v10, v32, 7, v33
    v_xor_b32_e64 v11, 64, v10
    v_add_u32 v14, 4096, v4
    v_lshlrev_b32 v32, 2, v2
    v_and_b32 v32, 16, v32
    v_and_b32_e64 v33, 1, v2
    v_lshl_add_u32 v32, v33, 3, v32
    v_bfe_u32 v33, v2, 1, 1
    v_lshrrev_b32_e64 v34, 3, v2
    v_lshl_add_u32 v33, v34, 1, v33
    v_add_lshl_u32 v100, v32, v33, 4
    v_min_u32_e64 v101, 47, v1
    v_lshlrev_b32 v101, 4, v101
    s_lshl_b32 s10, s4, 2
    s_add_u32 s10, s10, s3
    s_lshl_b32 s10, s10, 9
    s_add_u32 s99, s10, 0xa00000
    s_lshl_b32 s10, s5, 2
    s_add_u32 s10, s10, s3
    s_mul_i32 s10, s10, 3072
    s_add_u32 s100, s10, 0xa10000
    s_lshl_b32 s10, s5, 5
    s_add_u32 s10, s10, s4
    s_lshl_b32 s10, s10, 9
    s_add_u32 s101, s10, 0xa40000
    v_lshlrev_b32 v126, 4, v2
    v_lshl_add_u32 v126, v3, 12, v126
    s_lshl_b32 s10, s3, 2
    v_mov_b32_e64 v12, s10
    s_add_u32 s0, s95, 1
    s_and_b32 s0, s0, 7
    s_lshl_b32 s0, s0, 7
    s_add_u32 m0, s91, 24576
    s_add_u32 s1, s0, s88
    buffer_load_dwordx4 v16, s[52:55], s1 offen offset:0  lds
    buffer_load_dwordx4 v17, s[52:55], s1 offen offset:1024  lds
    buffer_load_dwordx4 v18, s[52:55], s1 offen offset:2048  lds
    buffer_load_dwordx4 v19, s[52:55], s1 offen offset:3072  lds
    s_add_u32 m0, s92, 40960
    s_add_u32 s1, s0, s89
    buffer_load_dwordx4 v20, s[56:59], s1 offen offset:0  lds
    buffer_load_dwordx4 v21, s[56:59], s1 offen offset:1024  lds
    s_add_u32 s0, s95, 2
    s_and_b32 s0, s0, 7
    s_lshl_b32 s0, s0, 7
    s_add_u32 m0, s91, 49152
    s_add_u32 s1, s0, s88
    buffer_load_dwordx4 v16, s[52:55], s1 offen offset:0  lds
    buffer_load_dwordx4 v17, s[52:55], s1 offen offset:1024  lds
    buffer_load_dwordx4 v18, s[52:55], s1 offen offset:2048  lds
    buffer_load_dwordx4 v19, s[52:55], s1 offen offset:3072  lds
    s_add_u32 m0, s92, 65536
    s_add_u32 s1, s0, s89
    buffer_load_dwordx4 v20, s[56:59], s1 offen offset:0  lds
    buffer_load_dwordx4 v21, s[56:59], s1 offen offset:1024  lds
    s_add_u32 s0, s95, 3
    s_and_b32 s0, s0, 7
    s_lshl_b32 s0, s0, 7
    s_add_u32 m0, s91, 73728
    s_add_u32 s1, s0, s88
    buffer_load_dwordx4 v16, s[52:55], s1 offen offset:0  lds
    buffer_load_dwordx4 v17, s[52:55], s1 offen offset:1024  lds
    buffer_load_dwordx4 v18, s[52:55], s1 offen offset:2048  lds
    buffer_load_dwordx4 v19, s[52:55], s1 offen offset:3072  lds
    s_add_u32 m0, s92, 90112
    s_add_u32 s1, s0, s89
    buffer_load_dwordx4 v20, s[56:59], s1 offen offset:0  lds
    buffer_load_dwordx4 v21, s[56:59], s1 offen offset:1024  lds
    s_waitcnt vmcnt(18)
    s_barrier
    global_load_ushort v68, v39, s[18:19]
    global_load_ushort v69, v39, s[20:21]
    global_load_ushort v70, v39, s[30:31]
    s_add_u32 s0, s95, 4
    s_and_b32 s0, s0, 7
    s_lshl_b32 s0, s0, 7
    s_add_u32 m0, s91, 98304
    s_add_u32 s1, s0, s88
    buffer_load_dwordx4 v16, s[52:55], s1 offen offset:0  lds
    buffer_load_dwordx4 v17, s[52:55], s1 offen offset:1024  lds
    buffer_load_dwordx4 v18, s[52:55], s1 offen offset:2048  lds
    buffer_load_dwordx4 v19, s[52:55], s1 offen offset:3072  lds
    s_add_u32 m0, s92, 114688
    s_add_u32 s1, s0, s89
    buffer_load_dwordx4 v20, s[56:59], s1 offen offset:0  lds
    buffer_load_dwordx4 v21, s[56:59], s1 offen offset:1024  lds
    s_waitcnt vmcnt(21)
    s_barrier
    s_add_u32 s0, s95, 5
    s_and_b32 s0, s0, 7
    s_lshl_b32 s0, s0, 7
    s_add_u32 m0, s91, 122880
    s_add_u32 s1, s0, s88
    buffer_load_dwordx4 v16, s[52:55], s1 offen offset:0  lds
    buffer_load_dwordx4 v17, s[52:55], s1 offen offset:1024  lds
    buffer_load_dwordx4 v18, s[52:55], s1 offen offset:2048  lds
    buffer_load_dwordx4 v19, s[52:55], s1 offen offset:3072  lds
    s_add_u32 m0, s92, 139264
    s_add_u32 s1, s0, s89
    buffer_load_dwordx4 v20, s[56:59], s1 offen offset:0  lds
    buffer_load_dwordx4 v21, s[56:59], s1 offen offset:1024  lds
    s_waitcnt vmcnt(21)
    s_barrier
    s_waitcnt vmcnt(12)
    s_add_u32 s0, s95, 6
    s_and_b32 s0, s0, 7
    s_lshl_b32 s0, s0, 7
    s_add_u32 m0, s91, 0
    s_add_u32 s1, s0, s88
    buffer_load_dwordx4 v16, s[52:55], s1 offen offset:0  lds
    buffer_load_dwordx4 v17, s[52:55], s1 offen offset:1024  lds
    buffer_load_dwordx4 v18, s[52:55], s1 offen offset:2048  lds
    buffer_load_dwordx4 v19, s[52:55], s1 offen offset:3072  lds
    s_add_u32 m0, s92, 16384
    s_add_u32 s1, s0, s89
    buffer_load_dwordx4 v20, s[56:59], s1 offen offset:0  lds
    buffer_load_dwordx4 v21, s[56:59], s1 offen offset:1024  lds
    v_lshlrev_b32 v68, 16, v68
    v_lshlrev_b32 v69, 16, v69
    v_lshlrev_b32 v70, 16, v70
    v_mul_f32 v70, 0x3fb8aa3b, v70
    v_exp_f32 v70, v70
    v_mul_f32 v34, v68, v68
    v_cvt_pk_bf16_f32 v70, v70, v70
    v_fma_f32 v34, v69, v69, v34
    v_lshlrev_b32 v70, 16, v70
    v_rcp_f32 v34, v34
    v_mul_f32 v32, v70, v68
    v_mul_f32 v33, v70, v69
    v_mul_f32 v32, 0x3fb8aa3b, v32
    v_mul_f32 v33, 0.15915494, v33
    v_exp_f32 v32, v32
    v_rndne_f32 v35, v33
    s_barrier
    buffer_load_dwordx4 v[80:83], v100, s[64:67], s99 offen sc1
    buffer_load_dwordx4 v[84:87], v101, s[64:67], s100 offen offset:0 sc1
    buffer_load_dwordx4 v[88:91], v101, s[64:67], s100 offen offset:768 sc1
    buffer_load_dwordx4 v[92:95], v101, s[64:67], s100 offen offset:1536 sc1
    buffer_load_dwordx4 v[96:99], v101, s[64:67], s100 offen offset:2304 sc1
    s_add_u32 s0, s95, 7
    s_and_b32 s0, s0, 7
    s_lshl_b32 s0, s0, 7
    s_add_u32 m0, s91, 24576
    s_add_u32 s1, s0, s88
    buffer_load_dwordx4 v16, s[52:55], s1 offen offset:0  lds
    buffer_load_dwordx4 v17, s[52:55], s1 offen offset:1024  lds
    buffer_load_dwordx4 v18, s[52:55], s1 offen offset:2048  lds
    buffer_load_dwordx4 v19, s[52:55], s1 offen offset:3072  lds
    s_add_u32 m0, s92, 40960
    s_add_u32 s1, s0, s89
    buffer_load_dwordx4 v20, s[56:59], s1 offen offset:0  lds
    buffer_load_dwordx4 v21, s[56:59], s1 offen offset:1024  lds
    v_sub_f32 v33, v33, v35
    v_add_f32 v34, v34, v34
    v_cos_f32 v72, v33
    v_sin_f32 v73, v33
    v_mul_f32 v72, v72, v32
    v_mul_f32 v73, v73, v32
    v_mul_f32 v32, v73, v73
    v_mul_f32_e64 v33, v72, v73
    v_fma_f32 v74, v72, v72, -v32
    v_add_f32 v75, v33, v33
    v_mul_f32 v32, v75, v75
    v_mul_f32_e64 v33, v74, v75
    v_fma_f32 v76, v74, v74, -v32
    v_add_f32 v77, v33, v33
    v_mul_f32 v32, v77, v77
    v_mul_f32_e64 v33, v76, v77
    s_waitcnt vmcnt(23)
    s_barrier
    s_lshr_b32 s0, s3, 1
    s_add_u32 s0, s0, s95
    s_add_u32 s0, s0, 0
    s_and_b32 s0, s0, 7
    s_mul_i32 s0, s0, 176128
    s_add_u32 m0, s92, 65536
    s_add_u32 s0, s0, s90
    s_add_u32 s0, s0, 0
    buffer_load_dwordx4 v24, s[60:63], s0 offen offset:0  lds
    buffer_load_dwordx4 v25, s[60:63], s0 offen offset:1024  lds
    s_lshr_b32 s0, s3, 1
    s_add_u32 s0, s0, s95
    s_add_u32 s0, s0, 0
    s_and_b32 s0, s0, 7
    s_mul_i32 s0, s0, 176128
    s_add_u32 m0, s92, 98304
    s_add_u32 s0, s0, s90
    s_add_u32 s0, s0, 64
    buffer_load_dwordx4 v24, s[60:63], s0 offen offset:0  lds
    buffer_load_dwordx4 v25, s[60:63], s0 offen offset:1024  lds
    v_fma_f32 v74, v76, v76, -v32
    v_add_f32 v75, v33, v33
    v_mul_f32 v32, v75, v75
    v_mul_f32_e64 v33, v74, v75
    v_fma_f32 v76, v74, v74, -v32
    v_add_f32 v77, v33, v33
    v_mul_f32 v32, v77, v77
    v_mul_f32_e64 v33, v76, v77
    v_fma_f32 v74, v76, v76, -v32
    v_add_f32 v75, v33, v33
    v_mul_f32 v32, v75, v75
    v_mul_f32_e64 v33, v74, v75
    v_fma_f32 v76, v74, v74, -v32
    v_add_f32 v77, v33, v33
    v_mul_f32 v32, v77, v77
    v_mul_f32 v33, v76, v77
    s_waitcnt vmcnt(21)
    s_barrier
    s_lshr_b32 s0, s3, 1
    s_add_u32 s0, s0, s95
    s_add_u32 s0, s0, 0
    s_and_b32 s0, s0, 7
    s_mul_i32 s0, s0, 176128
    s_add_u32 m0, s92, 131072
    s_add_u32 s0, s0, s90
    s_add_u32 s0, s0, 128
    buffer_load_dwordx4 v24, s[60:63], s0 offen offset:0  lds
    buffer_load_dwordx4 v25, s[60:63], s0 offen offset:1024  lds
    v_fma_f32 v122, v76, v76, -v32
    v_add_f32 v123, v33, v33
    v_mul_f32 v32, v123, v123
    v_mul_f32_e64 v33, v122, v123
    v_fma_f32 v74, v122, v122, -v32
    v_add_f32 v75, v33, v33
    v_mul_f32 v32, v75, v75
    v_mul_f32_e64 v33, v74, v75
    v_fma_f32 v76, v74, v74, -v32
    v_add_f32 v77, v33, v33
    v_mul_f32 v32, v77, v77
    v_mul_f32_e64 v33, v76, v77
    v_fma_f32 v124, v76, v76, -v32
    v_add_f32_e64 v125, v33, v33
    s_waitcnt vmcnt(17)
    s_barrier
    s_lshr_b32 s0, s3, 1
    s_add_u32 s0, s0, s95
    s_add_u32 s0, s0, 2
    s_and_b32 s0, s0, 7
    s_mul_i32 s0, s0, 176128
    s_add_u32 m0, s92, 73728
    s_add_u32 s0, s0, s90
    s_add_u32 s0, s0, 0
    buffer_load_dwordx4 v24, s[60:63], s0 offen offset:0  lds
    buffer_load_dwordx4 v25, s[60:63], s0 offen offset:1024  lds
    s_lshr_b32 s0, s3, 1
    s_add_u32 s0, s0, s95
    s_add_u32 s0, s0, 2
    s_and_b32 s0, s0, 7
    s_mul_i32 s0, s0, 176128
    s_add_u32 m0, s92, 106496
    s_add_u32 s0, s0, s90
    s_add_u32 s0, s0, 64
    buffer_load_dwordx4 v24, s[60:63], s0 offen offset:0  lds
    buffer_load_dwordx4 v25, s[60:63], s0 offen offset:1024  lds
    s_lshr_b32 s0, s3, 1
    s_add_u32 s0, s0, s95
    s_add_u32 s0, s0, 2
    s_and_b32 s0, s0, 7
    s_mul_i32 s0, s0, 176128
    s_add_u32 m0, s92, 139264
    s_add_u32 s0, s0, s90
    s_add_u32 s0, s0, 128
    buffer_load_dwordx4 v24, s[60:63], s0 offen offset:0  lds
    buffer_load_dwordx4 v25, s[60:63], s0 offen offset:1024  lds
    s_waitcnt vmcnt(18)
    s_waitcnt lgkmcnt(0)
    s_add_u32 s8, s8, 0x9e3779b9
    s_add_u32 s9, s9, 0x9e3779b9
    v_xor_b32 v32, s8, v81
    v_bitop3_b32 v32, v32, v83, s8 bitop3:0xf6
    v_bitop3_b32 v32, v32, v85, s9 bitop3:0xf6
    v_bitop3_b32 v32, v32, v87, s9 bitop3:0xf6
    v_bitop3_b32 v32, v32, v89, s9 bitop3:0xf6
    v_bitop3_b32 v32, v32, v91, s9 bitop3:0xf6
    v_bitop3_b32 v32, v32, v93, s9 bitop3:0xf6
    v_bitop3_b32 v32, v32, v95, s9 bitop3:0xf6
    v_bitop3_b32 v32, v32, v97, s9 bitop3:0xf6
    v_bitop3_b32 v32, v32, v99, s9 bitop3:0xf6
    v_cmp_ne_u32 vcc, 0, v32
    s_cbranch_vccnz L_bretry_1
L_bback_2:
    v_add_f32 v84, v84, v88
    v_add_f32 v86, v86, v90
    v_add_f32_e64 v92, v92, v96
    v_add_f32 v94, v94, v98
    s_lshl_b32 s10, s3, 2
    v_lshl_add_u32 v101, v101, 1, s10
    v_add_u32 v101, 13568, v101
    v_add_f32 v84, v84, v92
    v_add_f32 v85, v86, v94
    ds_write2_b32 v101, v84, v85 offset0:0 offset1:4
    v_mov_b32 v81, v82
    s_lshl_b32 s10, s3, 8
    v_lshl_add_u32 v100, v2, 3, s10
    ds_write_b64 v100, v[80:81] offset:8192
    v_mov_b32_e64 v32, 1
    ds_write_b32 v12, v32 offset:9520
    s_waitcnt vmcnt(12)
    s_barrier
    s_lshr_b32 s0, s3, 1
    s_add_u32 s0, s0, s95
    s_add_u32 s0, s0, 4
    s_and_b32 s0, s0, 7
    s_mul_i32 s0, s0, 176128
    s_add_u32 m0, s92, 81920
    s_add_u32 s0, s0, s90
    s_add_u32 s0, s0, 0
    buffer_load_dwordx4 v24, s[60:63], s0 offen offset:0  lds
    buffer_load_dwordx4 v25, s[60:63], s0 offen offset:1024  lds
    s_lshr_b32 s0, s3, 1
    s_add_u32 s0, s0, s95
    s_add_u32 s0, s0, 4
    s_and_b32 s0, s0, 7
    s_mul_i32 s0, s0, 176128
    s_add_u32 m0, s92, 114688
    s_add_u32 s0, s0, s90
    s_add_u32 s0, s0, 64
    buffer_load_dwordx4 v24, s[60:63], s0 offen offset:0  lds
    buffer_load_dwordx4 v25, s[60:63], s0 offen offset:1024  lds
    s_lshr_b32 s0, s3, 1
    s_add_u32 s0, s0, s95
    s_add_u32 s0, s0, 4
    s_and_b32 s0, s0, 7
    s_mul_i32 s0, s0, 176128
    s_add_u32 m0, s92, 147456
    s_add_u32 s0, s0, s90
    s_add_u32 s0, s0, 128
    buffer_load_dwordx4 v24, s[60:63], s0 offen offset:0  lds
    buffer_load_dwordx4 v25, s[60:63], s0 offen offset:1024  lds
    s_waitcnt vmcnt(12)
    s_barrier
    v_mov_b32 v6, v26
    v_mov_b32 v7, v27
    v_mov_b32 v116, v20
    v_mov_b32_e64 v117, v21
    s_lshr_b32 s0, s3, 1
    s_add_u32 s0, s0, s95
    s_add_u32 s0, s0, 6
    s_and_b32 s0, s0, 7
    s_mul_i32 s0, s0, 176128
    s_add_u32 m0, s92, 90112
    s_add_u32 s0, s0, s90
    s_add_u32 s0, s0, 0
    buffer_load_dwordx4 v24, s[60:63], s0 offen offset:0  lds
    buffer_load_dwordx4 v25, s[60:63], s0 offen offset:1024  lds
    s_lshr_b32 s0, s3, 1
    s_add_u32 s0, s0, s95
    s_add_u32 s0, s0, 6
    s_and_b32 s0, s0, 7
    s_mul_i32 s0, s0, 176128
    s_add_u32 m0, s92, 122880
    s_add_u32 s0, s0, s90
    s_add_u32 s0, s0, 64
    s_waitcnt vmcnt(13)
    buffer_load_dwordx4 v24, s[60:63], s0 offen offset:0  lds
    buffer_load_dwordx4 v25, s[60:63], s0 offen offset:1024  lds
    s_lshr_b32 s0, s3, 1
    s_add_u32 s0, s0, s95
    s_add_u32 s0, s0, 6
    s_and_b32 s0, s0, 7
    s_mul_i32 s0, s0, 176128
    s_add_u32 m0, s92, 155648
    s_add_u32 s0, s0, s90
    s_add_u32 s0, s0, 128
    s_waitcnt vmcnt(13)
    buffer_load_dwordx4 v24, s[60:63], s0 offen offset:0  lds
    buffer_load_dwordx4 v25, s[60:63], s0 offen offset:1024  lds
    s_waitcnt vmcnt(12)
    v_mov_b32_e64 v13, 6
    ds_write_b32 v12, v13 offset:9472
    s_lshl_b32 s1, s2, 1
    s_add_u32 s1, s1, s3
    s_cmp_lt_u32 s3, 2
    s_cselect_b32 s0, 22, 16
    s_cselect_b32 s1, s1, s2
    s_mul_i32 s1, s0, s1
    s_sub_u32 s0, s0, 1
    v_min_u32 v26, s0, v1
    v_add_lshl_u32 v26, v26, s1, 7
    s_cmp_eq_u32 s3, 2
    s_cselect_b64 s[78:79], s[26:27], s[28:29]
    s_cmp_lt_u32 s3, 2
    s_cselect_b64 s[0:1], s[40:41], s[78:79]
    v_min_u32 v26, 1408896, v26
    s_mov_b64 exec, 0x3fffff
    global_load_dword v27, v26, s[0:1]
    s_mov_b64 exec, -1
    s_waitcnt vmcnt(7)
    v_mov_b32 v13, 9
    ds_write_b32 v12, v13 offset:9472
    s_add_u32 s0, s94, 0
    s_bitcmp1_b32 s0, 0
    s_cselect_b32 s72, s28, s26
    s_cselect_b32 s1, s29, s27
    s_and_b32 s73, s1, 0xffff
    s_and_b32 s0, s0, 2
    s_lshl_b32 s0, s0, 6
    s_add_u32 s0, s0, s35
    s_add_u32 m0, s34, 0
    s_add_u32 s0, s0, 0
    buffer_load_dwordx4 v20, s[72:75], s0 offen offset:0  lds
    buffer_load_dwordx4 v21, s[72:75], s0 offen offset:1024  lds
    buffer_load_dwordx4 v22, s[72:75], s0 offen offset:2048  lds
    buffer_load_dwordx4 v23, s[72:75], s0 offen offset:3072  lds
    s_waitcnt vmcnt(5)
    v_mov_b32_e64 v13, 12
    ds_write_b32 v12, v13 offset:9472
    s_add_u32 s0, s94, 0
    s_bitcmp1_b32 s0, 0
    s_cselect_b32 s72, s28, s26
    s_cselect_b32 s1, s29, s27
    s_and_b32 s73, s1, 0xffff
    s_and_b32 s0, s0, 2
    s_lshl_b32 s0, s0, 6
    s_add_u32 s0, s0, s35
    s_add_u32 m0, s34, 16384
    s_add_u32 s0, s0, 32768
    buffer_load_dwordx4 v20, s[72:75], s0 offen offset:0  lds
    buffer_load_dwordx4 v21, s[72:75], s0 offen offset:1024  lds
    buffer_load_dwordx4 v22, s[72:75], s0 offen offset:2048  lds
    buffer_load_dwordx4 v23, s[72:75], s0 offen offset:3072  lds
    s_add_u32 s0, s94, 1
    s_bitcmp1_b32 s0, 0
    s_cselect_b32 s72, s28, s26
    s_cselect_b32 s1, s29, s27
    s_and_b32 s73, s1, 0xffff
    s_and_b32 s0, s0, 2
    s_lshl_b32 s0, s0, 6
    s_add_u32 s0, s0, s35
    s_add_u32 m0, s34, 32768
    s_add_u32 s0, s0, 0
    buffer_load_dwordx4 v20, s[72:75], s0 offen offset:0  lds
    buffer_load_dwordx4 v21, s[72:75], s0 offen offset:1024  lds
    buffer_load_dwordx4 v22, s[72:75], s0 offen offset:2048  lds
    buffer_load_dwordx4 v23, s[72:75], s0 offen offset:3072  lds
    s_waitcnt vmcnt(8)
    ds_read_b128 v[32:35], v112 offset:0
    ds_read_b128 v[36:39], v113 offset:0
    ds_read_b128 v[40:43], v114 offset:0
    ds_read_b128 v[44:47], v115 offset:0
    s_waitcnt lgkmcnt(0)
    s_add_u32 s0, s94, 1
    s_bitcmp1_b32 s0, 0
    s_cselect_b32 s72, s28, s26
    s_cselect_b32 s1, s29, s27
    s_and_b32 s73, s1, 0xffff
    s_and_b32 s0, s0, 2
    s_lshl_b32 s0, s0, 6
    s_add_u32 s0, s0, s35
    s_add_u32 m0, s34, 0
    s_add_u32 s0, s0, 32768
    buffer_load_dwordx4 v20, s[72:75], s0 offen offset:0  lds
    buffer_load_dwordx4 v21, s[72:75], s0 offen offset:1024  lds
    buffer_load_dwordx4 v22, s[72:75], s0 offen offset:2048  lds
    buffer_load_dwordx4 v23, s[72:75], s0 offen offset:3072  lds
    s_waitcnt vmcnt(8)
    ds_read_b128 v[48:51], v112 offset:16384
    ds_read_b128 v[52:55], v113 offset:16384
    ds_read_b128 v[56:59], v114 offset:16384
    ds_read_b128 v[60:63], v115 offset:16384
    s_waitcnt lgkmcnt(0)
    s_add_u32 s0, s94, 2
    s_bitcmp1_b32 s0, 0
    s_cselect_b32 s72, s28, s26
    s_cselect_b32 s1, s29, s27
    s_and_b32 s73, s1, 0xffff
    s_and_b32 s0, s0, 2
    s_lshl_b32 s0, s0, 6
    s_add_u32 s0, s0, s35
    s_add_u32 m0, s34, 16384
    s_add_u32 s0, s0, 0
    buffer_load_dwordx4 v20, s[72:75], s0 offen offset:0  lds
    buffer_load_dwordx4 v21, s[72:75], s0 offen offset:1024  lds
    buffer_load_dwordx4 v22, s[72:75], s0 offen offset:2048  lds
    buffer_load_dwordx4 v23, s[72:75], s0 offen offset:3072  lds
    s_cmp_lg_u32 s3, 3
    s_cbranch_scc1 L_bE1_3
    buffer_load_dwordx4 a[0:3], v126, s[64:67], s101 offen offset:0 sc1
    buffer_load_dwordx4 a[4:7], v126, s[64:67], s101 offen offset:512 sc1
    buffer_load_dwordx4 a[8:11], v126, s[64:67], s101 offen offset:1024 sc1
    buffer_load_dwordx4 a[12:15], v126, s[64:67], s101 offen offset:1536 sc1
    buffer_load_dwordx4 a[16:19], v126, s[64:67], s101 offen offset:2048 sc1
    buffer_load_dwordx4 a[20:23], v126, s[64:67], s101 offen offset:2560 sc1
    buffer_load_dwordx4 a[24:27], v126, s[64:67], s101 offen offset:3072 sc1
    buffer_load_dwordx4 a[28:31], v126, s[64:67], s101 offen offset:3584 sc1
L_bE1_3:
    s_cmp_lg_u32 s3, 3
    s_cbranch_scc1 L_bE2_4
    s_setprio 3
    s_waitcnt vmcnt(0)
    v_accvgpr_read_b32 v16, a1
    v_accvgpr_read_b32 v17, a3
    v_accvgpr_read_b32 v18, a5
    v_accvgpr_read_b32 v19, a7
    v_accvgpr_read_b32 v20, a9
    v_accvgpr_read_b32 v21, a11
    v_accvgpr_read_b32 v22, a13
    v_accvgpr_read_b32 v23, a15
    v_accvgpr_read_b32 v24, a17
    v_accvgpr_read_b32 v25, a19
    v_accvgpr_read_b32 v26, a21
    v_accvgpr_read_b32 v27, a23
    v_accvgpr_read_b32 v28, a25
    v_accvgpr_read_b32 v29, a27
    v_accvgpr_read_b32 v30, a29
    v_accvgpr_read_b32 v31, a31
    v_xor_b32_e64 v12, s9, v16
    v_bitop3_b32 v12, v12, v17, s9 bitop3:0xf6
    v_bitop3_b32 v12, v12, v18, s9 bitop3:0xf6
    v_bitop3_b32 v12, v12, v19, s9 bitop3:0xf6
    v_bitop3_b32 v12, v12, v20, s9 bitop3:0xf6
    v_bitop3_b32 v12, v12, v21, s9 bitop3:0xf6
    v_bitop3_b32 v12, v12, v22, s9 bitop3:0xf6
    v_bitop3_b32 v12, v12, v23, s9 bitop3:0xf6
    v_bitop3_b32 v12, v12, v24, s9 bitop3:0xf6
    v_bitop3_b32 v12, v12, v25, s9 bitop3:0xf6
    v_bitop3_b32 v12, v12, v26, s9 bitop3:0xf6
    v_bitop3_b32 v12, v12, v27, s9 bitop3:0xf6
    v_bitop3_b32 v12, v12, v28, s9 bitop3:0xf6
    v_bitop3_b32 v12, v12, v29, s9 bitop3:0xf6
    v_bitop3_b32 v12, v12, v30, s9 bitop3:0xf6
    v_bitop3_b32 v12, v12, v31, s9 bitop3:0xf6
    v_cmp_ne_u32 vcc, 0, v12
    s_cbranch_vccnz L_bretry_5
L_bback_6:
    v_accvgpr_read_b32 v16, a0
    v_accvgpr_read_b32 v17, a2
    v_accvgpr_read_b32 v18, a4
    v_accvgpr_read_b32 v19, a6
    v_accvgpr_read_b32 v20, a8
    v_accvgpr_read_b32 v21, a10
    v_accvgpr_read_b32 v22, a12
    v_accvgpr_read_b32 v23, a14
    v_accvgpr_read_b32 v24, a16
    v_accvgpr_read_b32 v25, a18
    v_accvgpr_read_b32 v26, a20
    v_accvgpr_read_b32 v27, a22
    v_accvgpr_read_b32 v28, a24
    v_accvgpr_read_b32 v29, a26
    v_accvgpr_read_b32 v30, a28
    v_accvgpr_read_b32 v31, a30
    v_fma_f32 v12, v122, v16, v18
    v_fma_f32 v13, v122, v17, v19
    v_fma_f32 v12, -v123, v17, v12
    v_fma_f32 v13, v123, v16, v13
    v_fma_f32 v16, v122, v12, v20
    v_fma_f32 v17, v122, v13, v21
    v_fma_f32 v16, -v123, v13, v16
    v_fma_f32 v17, v123, v12, v17
    v_fma_f32 v12, v122, v16, v22
    v_fma_f32 v13, v122, v17, v23
    v_fma_f32 v12, -v123, v17, v12
    v_fma_f32 v13, v123, v16, v13
    v_fma_f32 v16, v122, v12, v24
    v_fma_f32 v17, v122, v13, v25
    v_fma_f32 v16, -v123, v13, v16
    v_fma_f32 v17, v123, v12, v17
    v_fma_f32 v12, v122, v16, v26
    v_fma_f32 v13, v122, v17, v27
    v_fma_f32 v12, -v123, v17, v12
    v_fma_f32 v13, v123, v16, v13
    v_fma_f32 v16, v122, v12, v28
    v_fma_f32 v17, v122, v13, v29
    v_fma_f32 v16, -v123, v13, v16
    v_fma_f32 v17, v123, v12, v17
    v_fma_f32 v12, v122, v16, v30
    v_fma_f32 v13, v122, v17, v31
    v_fma_f32 v12, -v123, v17, v12
    v_fma_f32 v13, v123, v16, v13
    v_mov_b32 v16, v12
    v_mov_b32 v17, v13
    v_lshlrev_b32 v20, 3, v2
    v_permlane32_swap_b32 v12, v16
    v_permlane32_swap_b32_e64 v13, v17
    v_fma_f32 v18, v124, v12, v16
    v_fma_f32 v19, v124, v13, v17
    v_fma_f32 v18, -v125, v13, v18
    v_fma_f32 v19, v125, v12, v19
    ds_write_b64 v20, v[18:19] offset:9216
    v_mov_b32 v21, 0
    v_mov_b32 v22, 1
    ds_write_b32 v21, v22 offset:9536
    s_cmp_lg_u32 s4, 15
    s_cbranch_scc1 L_bn2_7
    s_mov_b64 exec, 1
    s_lshl_b32 s10, s5, 7
    s_add_u32 s10, s10, 0xb00800
    v_mov_b32 v16, s9
    v_mov_b32 v17, 0
    buffer_store_dword v16, v17, s[64:67], s10 offen
    s_mov_b64 exec, -1
L_bn2_7:
    s_setprio 0
L_bE2_4:
    v_mov_b32_e64 v20, v116
    v_mov_b32 v21, v117
    v_add_u32 v22, 14336, v116
    v_add_u32 v23, 14336, v117
    s_waitcnt vmcnt(4)
    ds_read_b128 v[64:67], v112 offset:32768
    ds_read_b128 v[68:71], v113 offset:32768
    ds_read_b128 v[72:75], v114 offset:32768
    ds_read_b128 v[76:79], v115 offset:32768
    ds_read_b128 v[80:83], v112 offset:0
    ds_read_b128 v[84:87], v113 offset:0
    ds_read_b128 v[88:91], v114 offset:0
    ds_read_b128 v[92:95], v115 offset:0
    s_waitcnt lgkmcnt(0)
    s_add_u32 s0, s94, 3
    s_bitcmp1_b32 s0, 0
    s_cselect_b32 s72, s28, s26
    s_cselect_b32 s1, s29, s27
    s_and_b32 s73, s1, 0xffff
    s_and_b32 s0, s0, 2
    s_lshl_b32 s0, s0, 6
    s_add_u32 s0, s0, s35
    s_add_u32 m0, s34, 0
    s_add_u32 s0, s0, 0
    buffer_load_dwordx4 v20, s[72:75], s0 offen offset:0  lds
    buffer_load_dwordx4 v21, s[72:75], s0 offen offset:1024  lds
    buffer_load_dwordx4 v22, s[72:75], s0 offen offset:2048  lds
    buffer_load_dwordx4 v23, s[72:75], s0 offen offset:3072  lds
    s_add_u32 s0, s94, 2
    s_bitcmp1_b32 s0, 0
    s_cselect_b32 s72, s28, s26
    s_cselect_b32 s1, s29, s27
    s_and_b32 s73, s1, 0xffff
    s_and_b32 s0, s0, 2
    s_lshl_b32 s0, s0, 6
    s_add_u32 s0, s0, s35
    s_add_u32 m0, s34, 32768
    s_add_u32 s0, s0, 32768
    buffer_load_dwordx4 v20, s[72:75], s0 offen offset:0  lds
    buffer_load_dwordx4 v21, s[72:75], s0 offen offset:1024  lds
    buffer_load_dwordx4 v22, s[72:75], s0 offen offset:2048  lds
    buffer_load_dwordx4 v23, s[72:75], s0 offen offset:3072  lds
    ds_read_b128 v[28:31], v0 offset:9488
    s_waitcnt lgkmcnt(0)
    v_min3_u32 v28, v28, v29, v30
    v_min_u32_e64 v28, v28, v31
    v_cmp_gt_u32 vcc, 9, v28
    s_cbranch_vccnz L_blw_8
L_blwb_9:
    s_add_u32 s0, s68, 0
    s_lshl_b32 s0, s0, 7
    s_add_u32 m0, s93, 0
    s_or_b32 s0, s0, s97
    s_lshl_b32 s0, s0, 7
    buffer_load_dwordx4 v6, s[80:83], s0 offen offset:0  lds
    buffer_load_dwordx4 v7, s[80:83], s0 offen offset:1024  lds
    s_add_u32 m0, s93, 2048
    s_add_u32 s0, s0, 16384
    s_waitcnt vmcnt(13)
    buffer_load_dwordx4 v6, s[80:83], s0 offen offset:0  lds
    buffer_load_dwordx4 v7, s[80:83], s0 offen offset:1024  lds
    s_add_u32 s0, s69, 0
    s_lshl_b32 s0, s0, 7
    s_add_u32 m0, s93, 4096
    s_or_b32 s0, s0, s97
    s_lshl_b32 s0, s0, 7
    s_waitcnt vmcnt(13)
    buffer_load_dwordx4 v6, s[80:83], s0 offen offset:0  lds
    buffer_load_dwordx4 v7, s[80:83], s0 offen offset:1024  lds
    s_add_u32 m0, s93, 6144
    s_add_u32 s0, s0, 16384
    s_waitcnt vmcnt(13)
    buffer_load_dwordx4 v6, s[80:83], s0 offen offset:0  lds
    buffer_load_dwordx4 v7, s[80:83], s0 offen offset:1024  lds
    ds_read_b128 v[96:99], v112 offset:16384
    ds_read_b128 v[100:103], v113 offset:16384
    ds_read_b128 v[104:107], v114 offset:16384
    ds_read_b128 v[108:111], v115 offset:16384
    s_waitcnt lgkmcnt(0)
    s_add_u32 s0, s94, 3
    s_bitcmp1_b32 s0, 0
    s_cselect_b32 s72, s28, s26
    s_cselect_b32 s1, s29, s27
    s_and_b32 s73, s1, 0xffff
    s_and_b32 s0, s0, 2
    s_lshl_b32 s0, s0, 6
    s_add_u32 s0, s0, s35
    s_add_u32 m0, s34, 16384
    s_add_u32 s0, s0, 32768
    s_waitcnt vmcnt(13)
    buffer_load_dwordx4 v20, s[72:75], s0 offen offset:0  lds
    buffer_load_dwordx4 v21, s[72:75], s0 offen offset:1024  lds
    s_waitcnt vmcnt(13)
    buffer_load_dwordx4 v22, s[72:75], s0 offen offset:2048  lds
    buffer_load_dwordx4 v23, s[72:75], s0 offen offset:3072  lds
    s_waitcnt vmcnt(12)
    v_mov_b32 v1, v112
    v_xor_b32_e64 v13, 0, v1
    ds_read_b128 v[112:115], v13 offset:32768
    v_xor_b32_e64 v13, 32, v1
    ds_read_b128 v[116:119], v13 offset:32768
    v_xor_b32 v13, 64, v1
    ds_read_b128 v[120:123], v13 offset:32768
    v_xor_b32 v13, 96, v1
    ds_read_b128 v[124:127], v13 offset:32768
    s_waitcnt lgkmcnt(0)
    s_add_u32 s0, s70, 0
    s_lshl_b32 s0, s0, 7
    s_add_u32 m0, s34, 32768
    s_or_b32 s0, s0, s97
    s_lshl_b32 s0, s0, 7
    buffer_load_dwordx4 v6, s[80:83], s0 offen offset:0  lds
    buffer_load_dwordx4 v7, s[80:83], s0 offen offset:1024  lds
    s_add_u32 m0, s34, 34816
    s_add_u32 s0, s0, 16384
    s_waitcnt vmcnt(13)
    buffer_load_dwordx4 v6, s[80:83], s0 offen offset:0  lds
    buffer_load_dwordx4 v7, s[80:83], s0 offen offset:1024  lds
    ds_read_b128 v[28:31], v0 offset:9488
    s_waitcnt lgkmcnt(0)
    v_min3_u32 v28, v28, v29, v30
    v_min_u32 v28, v28, v31
    v_cmp_gt_u32 vcc, 10, v28
    s_cbranch_vccnz L_blw_10
L_blwb_11:
    s_add_u32 s0, s71, 0
    s_lshl_b32 s0, s0, 7
    s_add_u32 m0, s93, 32768
    s_or_b32 s0, s0, s97
    s_lshl_b32 s0, s0, 7
    s_waitcnt vmcnt(13)
    buffer_load_dwordx4 v6, s[80:83], s0 offen offset:0  lds
    buffer_load_dwordx4 v7, s[80:83], s0 offen offset:1024  lds
    s_add_u32 m0, s93, 34816
    s_add_u32 s0, s0, 16384
    s_waitcnt vmcnt(13)
    buffer_load_dwordx4 v6, s[80:83], s0 offen offset:0  lds
    buffer_load_dwordx4 v7, s[80:83], s0 offen offset:1024  lds
    s_add_u32 s0, s68, 2
    s_lshl_b32 s0, s0, 7
    s_add_u32 m0, s93, 36864
    s_or_b32 s0, s0, s97
    s_lshl_b32 s0, s0, 7
    s_waitcnt vmcnt(13)
    buffer_load_dwordx4 v6, s[80:83], s0 offen offset:0  lds
    buffer_load_dwordx4 v7, s[80:83], s0 offen offset:1024  lds
    s_add_u32 m0, s93, 38912
    s_add_u32 s0, s0, 16384
    s_waitcnt vmcnt(13)
    buffer_load_dwordx4 v6, s[80:83], s0 offen offset:0  lds
    buffer_load_dwordx4 v7, s[80:83], s0 offen offset:1024  lds
    ds_read_b128 v[28:31], v0 offset:9488
    s_waitcnt lgkmcnt(0)
    v_min3_u32 v28, v28, v29, v30
    v_min_u32 v28, v28, v31
    v_cmp_gt_u32 vcc, 11, v28
    s_cbranch_vccnz L_blw_12
L_blwb_13:
    s_add_u32 s0, s69, 2
    s_lshl_b32 s0, s0, 7
    s_add_u32 m0, s93, 65536
    s_or_b32 s0, s0, s97
    s_lshl_b32 s0, s0, 7
    s_waitcnt vmcnt(13)
    buffer_load_dwordx4 v6, s[80:83], s0 offen offset:0  lds
    buffer_load_dwordx4 v7, s[80:83], s0 offen offset:1024  lds
    s_add_u32 m0, s93, 67584
    s_add_u32 s0, s0, 16384
    s_waitcnt vmcnt(13)
    buffer_load_dwordx4 v6, s[80:83], s0 offen offset:0  lds
    buffer_load_dwordx4 v7, s[80:83], s0 offen offset:1024  lds
    s_add_u32 s1, s85, 0
    buffer_load_dword v8, v15, s[64:67], s1 offen sc1
    s_add_u32 s0, s70, 2
    s_lshl_b32 s0, s0, 7
    s_add_u32 m0, s93, 69632
    s_or_b32 s0, s0, s97
    s_lshl_b32 s0, s0, 7
    s_waitcnt vmcnt(13)
    buffer_load_dwordx4 v6, s[80:83], s0 offen offset:0  lds
    buffer_load_dwordx4 v7, s[80:83], s0 offen offset:1024  lds
    s_add_u32 m0, s93, 71680
    s_add_u32 s0, s0, 16384
    s_waitcnt vmcnt(13)
    buffer_load_dwordx4 v6, s[80:83], s0 offen offset:0  lds
    buffer_load_dwordx4 v7, s[80:83], s0 offen offset:1024  lds
    s_waitcnt vmcnt(4)
    v_cmp_ne_u32 vcc, s8, v8
    s_cbranch_vccnz L_bretry_14
L_bback_15:
    s_add_u32 s12, s68, 64
    s_lshl_b32 s12, s12, 10
    s_add_u32 s12, s12, s84
    s_add_u32 s13, s12, 153600
    buffer_load_dwordx4 a[64:67], v4, s[64:67], s12 offen offset:0 sc1
    buffer_load_dwordx4 a[68:71], v4, s[64:67], s13 offen offset:0 sc1
    buffer_load_dwordx4 a[72:75], v4, s[64:67], s12 offen offset:1024 sc1
    buffer_load_dwordx4 a[76:79], v4, s[64:67], s13 offen offset:1024 sc1
    s_add_u32 s1, s85, 8192
    buffer_load_dword v8, v15, s[64:67], s1 offen sc1
    s_add_u32 s12, s69, 64
    s_lshl_b32 s12, s12, 10
    s_add_u32 s12, s12, s84
    s_add_u32 s13, s12, 153600
    buffer_load_dwordx4 a[80:83], v4, s[64:67], s12 offen offset:0 sc1
    buffer_load_dwordx4 a[84:87], v4, s[64:67], s13 offen offset:0 sc1
    buffer_load_dwordx4 a[88:91], v4, s[64:67], s12 offen offset:1024 sc1
    buffer_load_dwordx4 a[92:95], v4, s[64:67], s13 offen offset:1024 sc1
    s_add_u32 s12, s70, 64
    s_lshl_b32 s12, s12, 10
    s_add_u32 s12, s12, s84
    s_add_u32 s13, s12, 153600
    buffer_load_dwordx4 a[96:99], v4, s[64:67], s12 offen offset:0 sc1
    buffer_load_dwordx4 a[100:103], v4, s[64:67], s13 offen offset:0 sc1
    buffer_load_dwordx4 a[104:107], v4, s[64:67], s12 offen offset:1024 sc1
    buffer_load_dwordx4 a[108:111], v4, s[64:67], s13 offen offset:1024 sc1
    s_add_u32 s12, s71, 64
    s_lshl_b32 s12, s12, 10
    s_add_u32 s12, s12, s84
    s_add_u32 s13, s12, 153600
    buffer_load_dwordx4 a[112:115], v4, s[64:67], s12 offen offset:0 sc1
    buffer_load_dwordx4 a[116:119], v4, s[64:67], s13 offen offset:0 sc1
    buffer_load_dwordx4 a[120:123], v4, s[64:67], s12 offen offset:1024 sc1
    buffer_load_dwordx4 a[124:127], v4, s[64:67], s13 offen offset:1024 sc1
    s_add_u32 s10, s93, 0
    v_add_u32_e64 v12, s10, v10
    v_add_u32 v13, s10, v11
    ds_read_b64_tr_b16 v[16:17], v12 offset:0
    ds_read_b64_tr_b16 v[18:19], v12 offset:1024
    ds_read_b64_tr_b16 v[20:21], v13 offset:0
    ds_read_b64_tr_b16 v[22:23], v13 offset:1024
    s_waitcnt vmcnt(15) lgkmcnt(0)
    v_mfma_f32_32x32x16_bf16 a[0:15], v[16:19], a[64:67], 0
    ds_read_b64_tr_b16 v[24:25], v12 offset:2048
    ds_read_b64_tr_b16 v[26:27], v12 offset:3072
    ds_read_b64_tr_b16 v[28:29], v13 offset:2048
    ds_read_b64_tr_b16 v[30:31], v13 offset:3072
    v_mfma_f32_32x32x16_bf16 a[16:31], v[16:19], a[68:71], 0
    v_mfma_f32_32x32x16_bf16 a[32:47], v[20:23], a[64:67], 0
    v_mfma_f32_32x32x16_bf16 a[48:63], v[20:23], a[68:71], 0
    s_waitcnt vmcnt(13) lgkmcnt(0)
    v_mfma_f32_32x32x16_bf16 a[0:15], v[24:27], a[72:75], a[0:15]
    s_add_u32 s10, s93, 4096
    v_add_u32 v12, s10, v10
    v_add_u32_e64 v13, s10, v11
    ds_read_b64_tr_b16 v[16:17], v12 offset:0
    ds_read_b64_tr_b16 v[18:19], v12 offset:1024
    ds_read_b64_tr_b16 v[20:21], v13 offset:0
    ds_read_b64_tr_b16 v[22:23], v13 offset:1024
    v_mfma_f32_32x32x16_bf16 a[16:31], v[24:27], a[76:79], a[16:31]
    s_waitcnt vmcnt(12)
    v_cmp_ne_u32 vcc, s8, v8
    s_cbranch_vccnz L_bretry_17
L_bback_18:
    s_add_u32 s12, s68, 66
    s_lshl_b32 s12, s12, 10
    s_add_u32 s12, s12, s84
    s_add_u32 s13, s12, 153600
    buffer_load_dwordx4 a[64:67], v4, s[64:67], s12 offen offset:0 sc1
    buffer_load_dwordx4 a[68:71], v4, s[64:67], s13 offen offset:0 sc1
    v_mfma_f32_32x32x16_bf16 a[32:47], v[28:31], a[72:75], a[32:47]
    v_mfma_f32_32x32x16_bf16 a[48:63], v[28:31], a[76:79], a[48:63]
    s_waitcnt vmcnt(12) lgkmcnt(0)
    v_mfma_f32_32x32x16_bf16 a[0:15], v[16:19], a[80:83], a[0:15]
    ds_read_b64_tr_b16 v[24:25], v12 offset:2048
    ds_read_b64_tr_b16 v[26:27], v12 offset:3072
    ds_read_b64_tr_b16 v[28:29], v13 offset:2048
    ds_read_b64_tr_b16 v[30:31], v13 offset:3072
    v_mfma_f32_32x32x16_bf16 a[16:31], v[16:19], a[84:87], a[16:31]
    buffer_load_dwordx4 a[72:75], v4, s[64:67], s12 offen offset:1024 sc1
    buffer_load_dwordx4 a[76:79], v4, s[64:67], s13 offen offset:1024 sc1
    v_mfma_f32_32x32x16_bf16 a[32:47], v[20:23], a[80:83], a[32:47]
    v_mfma_f32_32x32x16_bf16 a[48:63], v[20:23], a[84:87], a[48:63]
    s_add_u32 s0, s71, 2
    s_lshl_b32 s0, s0, 7
    s_add_u32 m0, s93, 0
    s_or_b32 s0, s0, s97
    s_lshl_b32 s0, s0, 7
    buffer_load_dwordx4 v6, s[80:83], s0 offen offset:0  lds
    buffer_load_dwordx4 v7, s[80:83], s0 offen offset:1024  lds
    s_add_u32 m0, s93, 2048
    s_add_u32 s0, s0, 16384
    buffer_load_dwordx4 v6, s[80:83], s0 offen offset:0  lds
    buffer_load_dwordx4 v7, s[80:83], s0 offen offset:1024  lds
    s_waitcnt vmcnt(16) lgkmcnt(0)
    v_mfma_f32_32x32x16_bf16 a[0:15], v[24:27], a[88:91], a[0:15]
    s_add_u32 s10, s34, 32768
    v_add_u32 v12, s10, v10
    v_add_u32 v13, s10, v11
    ds_read_b64_tr_b16 v[16:17], v12 offset:0
    ds_read_b64_tr_b16 v[18:19], v12 offset:1024
    ds_read_b64_tr_b16 v[20:21], v13 offset:0
    ds_read_b64_tr_b16 v[22:23], v13 offset:1024
    v_mfma_f32_32x32x16_bf16 a[16:31], v[24:27], a[92:95], a[16:31]
    s_add_u32 s1, s85, 16384
    buffer_load_dword v8, v15, s[64:67], s1 offen sc1
    s_add_u32 s12, s69, 66
    s_lshl_b32 s12, s12, 10
    s_add_u32 s12, s12, s84
    s_add_u32 s13, s12, 153600
    buffer_load_dwordx4 a[80:83], v4, s[64:67], s12 offen offset:0 sc1
    buffer_load_dwordx4 a[84:87], v4, s[64:67], s13 offen offset:0 sc1
    v_mfma_f32_32x32x16_bf16 a[32:47], v[28:31], a[88:91], a[32:47]
    v_mfma_f32_32x32x16_bf16 a[48:63], v[28:31], a[92:95], a[48:63]
    s_waitcnt vmcnt(17) lgkmcnt(0)
    v_mfma_f32_32x32x16_bf16 a[0:15], v[16:19], a[96:99], a[0:15]
    ds_read_b64_tr_b16 v[24:25], v12 offset:2048
    ds_read_b64_tr_b16 v[26:27], v12 offset:3072
    ds_read_b64_tr_b16 v[28:29], v13 offset:2048
    ds_read_b64_tr_b16 v[30:31], v13 offset:3072
    v_mfma_f32_32x32x16_bf16 a[16:31], v[16:19], a[100:103], a[16:31]
    buffer_load_dwordx4 a[88:91], v4, s[64:67], s12 offen offset:1024 sc1
    buffer_load_dwordx4 a[92:95], v4, s[64:67], s13 offen offset:1024 sc1
    v_mfma_f32_32x32x16_bf16 a[32:47], v[20:23], a[96:99], a[32:47]
    v_mfma_f32_32x32x16_bf16 a[48:63], v[20:23], a[100:103], a[48:63]
    s_waitcnt vmcnt(17) lgkmcnt(0)
    v_mfma_f32_32x32x16_bf16 a[0:15], v[24:27], a[104:107], a[0:15]
    s_add_u32 s10, s93, 32768
    v_add_u32 v12, s10, v10
    v_add_u32 v13, s10, v11
    ds_read_b64_tr_b16 v[16:17], v12 offset:0
    ds_read_b64_tr_b16 v[18:19], v12 offset:1024
    ds_read_b64_tr_b16 v[20:21], v13 offset:0
    ds_read_b64_tr_b16 v[22:23], v13 offset:1024
    v_mfma_f32_32x32x16_bf16 a[16:31], v[24:27], a[108:111], a[16:31]
    s_add_u32 s12, s70, 66
    s_lshl_b32 s12, s12, 10
    s_add_u32 s12, s12, s84
    s_add_u32 s13, s12, 153600
    buffer_load_dwordx4 a[96:99], v4, s[64:67], s12 offen offset:0 sc1
    buffer_load_dwordx4 a[100:103], v4, s[64:67], s13 offen offset:0 sc1
    v_mfma_f32_32x32x16_bf16 a[32:47], v[28:31], a[104:107], a[32:47]
    v_mfma_f32_32x32x16_bf16 a[48:63], v[28:31], a[108:111], a[48:63]
    s_waitcnt vmcnt(17) lgkmcnt(0)
    v_mfma_f32_32x32x16_bf16 a[0:15], v[16:19], a[112:115], a[0:15]
    ds_read_b64_tr_b16 v[24:25], v12 offset:2048
    ds_read_b64_tr_b16 v[26:27], v12 offset:3072
    ds_read_b64_tr_b16 v[28:29], v13 offset:2048
    ds_read_b64_tr_b16 v[30:31], v13 offset:3072
    v_mfma_f32_32x32x16_bf16 a[16:31], v[16:19], a[116:119], a[16:31]
    buffer_load_dwordx4 a[104:107], v4, s[64:67], s12 offen offset:1024 sc1
    buffer_load_dwordx4 a[108:111], v4, s[64:67], s13 offen offset:1024 sc1
    v_mfma_f32_32x32x16_bf16 a[32:47], v[20:23], a[112:115], a[32:47]
    v_mfma_f32_32x32x16_bf16 a[48:63], v[20:23], a[116:119], a[48:63]
    s_waitcnt vmcnt(17) lgkmcnt(0)
    v_mfma_f32_32x32x16_bf16 a[0:15], v[24:27], a[120:123], a[0:15]
    s_add_u32 s10, s93, 36864
    v_add_u32_e64 v12, s10, v10
    v_add_u32 v13, s10, v11
    ds_read_b64_tr_b16 v[16:17], v12 offset:0
    ds_read_b64_tr_b16 v[18:19], v12 offset:1024
    ds_read_b64_tr_b16 v[20:21], v13 offset:0
    ds_read_b64_tr_b16 v[22:23], v13 offset:1024
    v_mfma_f32_32x32x16_bf16 a[16:31], v[24:27], a[124:127], a[16:31]
    s_add_u32 s12, s71, 66
    s_lshl_b32 s12, s12, 10
    s_add_u32 s12, s12, s84
    s_add_u32 s13, s12, 153600
    buffer_load_dwordx4 a[112:115], v4, s[64:67], s12 offen offset:0 sc1
    buffer_load_dwordx4 a[116:119], v4, s[64:67], s13 offen offset:0 sc1
    v_mfma_f32_32x32x16_bf16 a[32:47], v[28:31], a[120:123], a[32:47]
    v_mfma_f32_32x32x16_bf16 a[48:63], v[28:31], a[124:127], a[48:63]
    s_waitcnt vmcnt(17) lgkmcnt(0)
    v_mfma_f32_32x32x16_bf16 a[0:15], v[16:19], a[64:67], a[0:15]
    ds_read_b64_tr_b16 v[24:25], v12 offset:2048
    ds_read_b64_tr_b16 v[26:27], v12 offset:3072
    ds_read_b64_tr_b16 v[28:29], v13 offset:2048
    ds_read_b64_tr_b16 v[30:31], v13 offset:3072
    v_mfma_f32_32x32x16_bf16 a[16:31], v[16:19], a[68:71], a[16:31]
    buffer_load_dwordx4 a[120:123], v4, s[64:67], s12 offen offset:1024 sc1
    buffer_load_dwordx4 a[124:127], v4, s[64:67], s13 offen offset:1024 sc1
    v_mfma_f32_32x32x16_bf16 a[32:47], v[20:23], a[64:67], a[32:47]
    v_mfma_f32_32x32x16_bf16 a[48:63], v[20:23], a[68:71], a[48:63]
    s_add_u32 s0, s96, 0
    s_lshl_b32 s0, s0, 7
    s_add_u32 m0, s93, 4096
    s_or_b32 s0, s0, s97
    s_lshl_b32 s0, s0, 7
    buffer_load_dwordx4 v6, s[80:83], s0 offen offset:0  lds
    buffer_load_dwordx4 v7, s[80:83], s0 offen offset:1024  lds
    s_add_u32 m0, s93, 6144
    s_add_u32 s0, s0, 16384
    buffer_load_dwordx4 v6, s[80:83], s0 offen offset:0  lds
    buffer_load_dwordx4 v7, s[80:83], s0 offen offset:1024  lds
    s_waitcnt vmcnt(21) lgkmcnt(0)
    v_mfma_f32_32x32x16_bf16 a[0:15], v[24:27], a[72:75], a[0:15]
    s_add_u32 s10, s93, 65536
    v_add_u32 v12, s10, v10
    v_add_u32_e64 v13, s10, v11
    ds_read_b64_tr_b16 v[16:17], v12 offset:0
    ds_read_b64_tr_b16 v[18:19], v12 offset:1024
    ds_read_b64_tr_b16 v[20:21], v13 offset:0
    ds_read_b64_tr_b16 v[22:23], v13 offset:1024
    v_mfma_f32_32x32x16_bf16 a[16:31], v[24:27], a[76:79], a[16:31]
    s_waitcnt vmcnt(16)
    v_cmp_ne_u32_e64 vcc, s8, v8
    s_cbranch_vccnz L_bretry_19
L_bback_20:
    s_add_u32 s0, s94, 0
    s_and_b32 s1, s0, 1
    s_and_b32 s0, s0, 2
    s_lshl_b32 s0, s0, 1
    s_add_u32 s0, s0, s1
    s_lshl_b32 s0, s0, 11
    s_lshl_b32 s12, s3, 14
    s_add_u32 s12, s12, s0
    s_add_u32 s12, s12, s84
    s_add_u32 s13, s12, 153600
    buffer_load_dwordx4 a[64:67], v4, s[64:67], s12 offen offset:0 sc1
    buffer_load_dwordx4 a[68:71], v4, s[64:67], s13 offen offset:0 sc1
    v_mfma_f32_32x32x16_bf16 a[32:47], v[28:31], a[72:75], a[32:47]
    v_mfma_f32_32x32x16_bf16 a[48:63], v[28:31], a[76:79], a[48:63]
    s_waitcnt vmcnt(16) lgkmcnt(0)
    v_mfma_f32_32x32x16_bf16 a[0:15], v[16:19], a[80:83], a[0:15]
    ds_read_b64_tr_b16 v[24:25], v12 offset:2048
    ds_read_b64_tr_b16 v[26:27], v12 offset:3072
    ds_read_b64_tr_b16 v[28:29], v13 offset:2048
    ds_read_b64_tr_b16 v[30:31], v13 offset:3072
    v_mfma_f32_32x32x16_bf16 a[16:31], v[16:19], a[84:87], a[16:31]
    buffer_load_dwordx4 a[72:75], v4, s[64:67], s12 offen offset:1024 sc1
    buffer_load_dwordx4 a[76:79], v4, s[64:67], s13 offen offset:1024 sc1
    v_mfma_f32_32x32x16_bf16 a[32:47], v[20:23], a[80:83], a[32:47]
    v_mfma_f32_32x32x16_bf16 a[48:63], v[20:23], a[84:87], a[48:63]
    s_waitcnt vmcnt(16) lgkmcnt(0)
    v_mfma_f32_32x32x16_bf16 a[0:15], v[24:27], a[88:91], a[0:15]
    s_add_u32 s10, s93, 69632
    v_add_u32 v12, s10, v10
    v_add_u32 v13, s10, v11
    ds_read_b64_tr_b16 v[16:17], v12 offset:0
    ds_read_b64_tr_b16 v[18:19], v12 offset:1024
    ds_read_b64_tr_b16 v[20:21], v13 offset:0
    ds_read_b64_tr_b16 v[22:23], v13 offset:1024
    v_mfma_f32_32x32x16_bf16 a[16:31], v[24:27], a[92:95], a[16:31]
    buffer_load_dwordx4 a[80:83], v14, s[64:67], s12 offen offset:0 sc1
    buffer_load_dwordx4 a[84:87], v14, s[64:67], s13 offen offset:0 sc1
    v_mfma_f32_32x32x16_bf16 a[32:47], v[28:31], a[88:91], a[32:47]
    v_mfma_f32_32x32x16_bf16 a[48:63], v[28:31], a[92:95], a[48:63]
    s_waitcnt vmcnt(16) lgkmcnt(0)
    v_mfma_f32_32x32x16_bf16 a[0:15], v[16:19], a[96:99], a[0:15]
    ds_read_b64_tr_b16 v[24:25], v12 offset:2048
    ds_read_b64_tr_b16 v[26:27], v12 offset:3072
    ds_read_b64_tr_b16 v[28:29], v13 offset:2048
    ds_read_b64_tr_b16 v[30:31], v13 offset:3072
    v_mfma_f32_32x32x16_bf16 a[16:31], v[16:19], a[100:103], a[16:31]
    buffer_load_dwordx4 a[88:91], v14, s[64:67], s12 offen offset:1024 sc1
    buffer_load_dwordx4 a[92:95], v14, s[64:67], s13 offen offset:1024 sc1
    v_mfma_f32_32x32x16_bf16 a[32:47], v[20:23], a[96:99], a[32:47]
    v_mfma_f32_32x32x16_bf16 a[48:63], v[20:23], a[100:103], a[48:63]
    s_waitcnt vmcnt(16) lgkmcnt(0)
    v_mfma_f32_32x32x16_bf16 a[0:15], v[24:27], a[104:107], a[0:15]
    s_add_u32 s10, s93, 0
    v_add_u32 v12, s10, v10
    v_add_u32 v13, s10, v11
    ds_read_b64_tr_b16 v[16:17], v12 offset:0
    ds_read_b64_tr_b16 v[18:19], v12 offset:1024
    ds_read_b64_tr_b16 v[20:21], v13 offset:0
    ds_read_b64_tr_b16 v[22:23], v13 offset:1024
    v_mfma_f32_32x32x16_bf16 a[16:31], v[24:27], a[108:111], a[16:31]
    s_add_u32 s0, s94, 1
    s_and_b32 s1, s0, 1
    s_and_b32 s0, s0, 2
    s_lshl_b32 s0, s0, 1
    s_add_u32 s0, s0, s1
    s_lshl_b32 s0, s0, 11
    s_lshl_b32 s12, s3, 14
    s_add_u32 s12, s12, s0
    s_add_u32 s12, s12, s84
    s_add_u32 s13, s12, 153600
    buffer_load_dwordx4 a[96:99], v4, s[64:67], s12 offen offset:0 sc1
    buffer_load_dwordx4 a[100:103], v4, s[64:67], s13 offen offset:0 sc1
    v_mfma_f32_32x32x16_bf16 a[32:47], v[28:31], a[104:107], a[32:47]
    v_mfma_f32_32x32x16_bf16 a[48:63], v[28:31], a[108:111], a[48:63]
    s_waitcnt vmcnt(16) lgkmcnt(0)
    v_mfma_f32_32x32x16_bf16 a[0:15], v[16:19], a[112:115], a[0:15]
    ds_read_b64_tr_b16 v[24:25], v12 offset:2048
    ds_read_b64_tr_b16 v[26:27], v12 offset:3072
    ds_read_b64_tr_b16 v[28:29], v13 offset:2048
    ds_read_b64_tr_b16 v[30:31], v13 offset:3072
    v_mfma_f32_32x32x16_bf16 a[16:31], v[16:19], a[116:119], a[16:31]
    buffer_load_dwordx4 a[104:107], v4, s[64:67], s12 offen offset:1024 sc1
    buffer_load_dwordx4 a[108:111], v4, s[64:67], s13 offen offset:1024 sc1
    v_mfma_f32_32x32x16_bf16 a[32:47], v[20:23], a[112:115], a[32:47]
    v_mfma_f32_32x32x16_bf16 a[48:63], v[20:23], a[116:119], a[48:63]
    s_add_u32 s0, s96, 6
    s_lshl_b32 s0, s0, 7
    s_add_u32 m0, s34, 32768
    s_or_b32 s0, s0, s97
    s_lshl_b32 s0, s0, 7
    buffer_load_dwordx4 v6, s[80:83], s0 offen offset:0  lds
    buffer_load_dwordx4 v7, s[80:83], s0 offen offset:1024  lds
    s_add_u32 m0, s34, 34816
    s_add_u32 s0, s0, 16384
    buffer_load_dwordx4 v6, s[80:83], s0 offen offset:0  lds
    buffer_load_dwordx4 v7, s[80:83], s0 offen offset:1024  lds
    s_waitcnt vmcnt(20) lgkmcnt(0)
    v_mfma_f32_32x32x16_bf16 a[0:15], v[24:27], a[120:123], a[0:15]
    v_mfma_f32_32x32x16_bf16 a[16:31], v[24:27], a[124:127], a[16:31]
    buffer_load_dwordx4 a[112:115], v14, s[64:67], s12 offen offset:0 sc1
    buffer_load_dwordx4 a[116:119], v14, s[64:67], s13 offen offset:0 sc1
    v_mfma_f32_32x32x16_bf16 a[32:47], v[28:31], a[120:123], a[32:47]
    v_mfma_f32_32x32x16_bf16 a[48:63], v[28:31], a[124:127], a[48:63]
    s_waitcnt vmcnt(16)
    v_mfma_f32_32x32x16_bf16 a[0:15], v[32:35], a[64:67], a[0:15]
    v_mfma_f32_32x32x16_bf16 a[16:31], v[32:35], a[68:71], a[16:31]
    buffer_load_dwordx4 a[120:123], v14, s[64:67], s12 offen offset:1024 sc1
    buffer_load_dwordx4 a[124:127], v14, s[64:67], s13 offen offset:1024 sc1
    v_mfma_f32_32x32x16_bf16 a[32:47], v[48:51], a[64:67], a[32:47]
    v_mfma_f32_32x32x16_bf16 a[48:63], v[48:51], a[68:71], a[48:63]
    s_waitcnt vmcnt(16)
    v_mfma_f32_32x32x16_bf16 a[0:15], v[36:39], a[72:75], a[0:15]
    v_mfma_f32_32x32x16_bf16 a[16:31], v[36:39], a[76:79], a[16:31]
    s_add_u32 s0, s94, 2
    s_and_b32 s1, s0, 1
    s_and_b32 s0, s0, 2
    s_lshl_b32 s0, s0, 1
    s_add_u32 s0, s0, s1
    s_lshl_b32 s0, s0, 11
    s_lshl_b32 s12, s3, 14
    s_add_u32 s12, s12, s0
    s_add_u32 s12, s12, s84
    s_add_u32 s13, s12, 153600
    buffer_load_dwordx4 a[64:67], v4, s[64:67], s12 offen offset:0 sc1
    buffer_load_dwordx4 a[68:71], v4, s[64:67], s13 offen offset:0 sc1
    v_mfma_f32_32x32x16_bf16 a[32:47], v[52:55], a[72:75], a[32:47]
    v_mfma_f32_32x32x16_bf16 a[48:63], v[52:55], a[76:79], a[48:63]
    s_waitcnt vmcnt(16)
    v_mfma_f32_32x32x16_bf16 a[0:15], v[40:43], a[80:83], a[0:15]
    v_mfma_f32_32x32x16_bf16 a[16:31], v[40:43], a[84:87], a[16:31]
    buffer_load_dwordx4 a[72:75], v4, s[64:67], s12 offen offset:1024 sc1
    buffer_load_dwordx4 a[76:79], v4, s[64:67], s13 offen offset:1024 sc1
    v_mfma_f32_32x32x16_bf16 a[32:47], v[56:59], a[80:83], a[32:47]
    v_mfma_f32_32x32x16_bf16 a[48:63], v[56:59], a[84:87], a[48:63]
    s_waitcnt vmcnt(16)
    v_mfma_f32_32x32x16_bf16 a[0:15], v[44:47], a[88:91], a[0:15]
    v_mfma_f32_32x32x16_bf16 a[16:31], v[44:47], a[92:95], a[16:31]
    s_add_u32 s1, s85, 24576
    buffer_load_dword v8, v9, s[64:67], s1 offen sc1
    buffer_load_dwordx4 a[80:83], v14, s[64:67], s12 offen offset:0 sc1
    buffer_load_dwordx4 a[84:87], v14, s[64:67], s13 offen offset:0 sc1
    v_mfma_f32_32x32x16_bf16 a[32:47], v[60:63], a[88:91], a[32:47]
    v_mfma_f32_32x32x16_bf16 a[48:63], v[60:63], a[92:95], a[48:63]
    s_waitcnt vmcnt(17)
    v_mfma_f32_32x32x16_bf16 a[0:15], v[64:67], a[96:99], a[0:15]
    v_mfma_f32_32x32x16_bf16 a[16:31], v[64:67], a[100:103], a[16:31]
    buffer_load_dwordx4 a[88:91], v14, s[64:67], s12 offen offset:1024 sc1
    buffer_load_dwordx4 a[92:95], v14, s[64:67], s13 offen offset:1024 sc1
    v_mfma_f32_32x32x16_bf16 a[32:47], v[80:83], a[96:99], a[32:47]
    v_mfma_f32_32x32x16_bf16 a[48:63], v[80:83], a[100:103], a[48:63]
    s_add_u32 s0, s7, 0
    s_lshl_b32 s0, s0, 7
    s_add_u32 m0, s93, 32768
    s_or_b32 s0, s0, s97
    s_lshl_b32 s0, s0, 7
    buffer_load_dwordx4 v6, s[80:83], s0 offen offset:0  lds
    buffer_load_dwordx4 v7, s[80:83], s0 offen offset:1024  lds
    s_add_u32 m0, s93, 34816
    s_add_u32 s0, s0, 16384
    buffer_load_dwordx4 v6, s[80:83], s0 offen offset:0  lds
    buffer_load_dwordx4 v7, s[80:83], s0 offen offset:1024  lds
    s_waitcnt vmcnt(21)
    v_mfma_f32_32x32x16_bf16 a[0:15], v[68:71], a[104:107], a[0:15]
    v_mfma_f32_32x32x16_bf16 a[16:31], v[68:71], a[108:111], a[16:31]
    s_add_u32 s0, s94, 3
    s_and_b32 s1, s0, 1
    s_and_b32 s0, s0, 2
    s_lshl_b32 s0, s0, 1
    s_add_u32 s0, s0, s1
    s_lshl_b32 s0, s0, 11
    s_lshl_b32 s12, s3, 14
    s_add_u32 s12, s12, s0
    s_add_u32 s12, s12, s84
    s_add_u32 s13, s12, 153600
    buffer_load_dwordx4 a[96:99], v4, s[64:67], s12 offen offset:0 sc1
    buffer_load_dwordx4 a[100:103], v4, s[64:67], s13 offen offset:0 sc1
    v_mfma_f32_32x32x16_bf16 a[32:47], v[84:87], a[104:107], a[32:47]
    v_mfma_f32_32x32x16_bf16 a[48:63], v[84:87], a[108:111], a[48:63]
    s_waitcnt vmcnt(17)
    v_mfma_f32_32x32x16_bf16 a[0:15], v[72:75], a[112:115], a[0:15]
    v_mfma_f32_32x32x16_bf16 a[16:31], v[72:75], a[116:119], a[16:31]
    buffer_load_dwordx4 a[104:107], v4, s[64:67], s12 offen offset:1024 sc1
    buffer_load_dwordx4 a[108:111], v4, s[64:67], s13 offen offset:1024 sc1
    v_mfma_f32_32x32x16_bf16 a[32:47], v[88:91], a[112:115], a[32:47]
    v_mfma_f32_32x32x16_bf16 a[48:63], v[88:91], a[116:119], a[48:63]
    s_waitcnt vmcnt(17)
    v_mfma_f32_32x32x16_bf16 a[0:15], v[76:79], a[120:123], a[0:15]
    v_mfma_f32_32x32x16_bf16 a[16:31], v[76:79], a[124:127], a[16:31]
    buffer_load_dwordx4 a[112:115], v14, s[64:67], s12 offen offset:0 sc1
    buffer_load_dwordx4 a[116:119], v14, s[64:67], s13 offen offset:0 sc1
    v_mfma_f32_32x32x16_bf16 a[32:47], v[92:95], a[120:123], a[32:47]
    v_mfma_f32_32x32x16_bf16 a[48:63], v[92:95], a[124:127], a[48:63]
    s_waitcnt vmcnt(17)
    v_mfma_f32_32x32x16_bf16 a[0:15], v[96:99], a[64:67], a[0:15]
    v_mfma_f32_32x32x16_bf16 a[16:31], v[96:99], a[68:71], a[16:31]
    buffer_load_dwordx4 a[120:123], v14, s[64:67], s12 offen offset:1024 sc1
    buffer_load_dwordx4 a[124:127], v14, s[64:67], s13 offen offset:1024 sc1
    v_mfma_f32_32x32x16_bf16 a[32:47], v[112:115], a[64:67], a[32:47]
    v_mfma_f32_32x32x16_bf16 a[48:63], v[112:115], a[68:71], a[48:63]
    s_waitcnt vmcnt(17)
    v_mfma_f32_32x32x16_bf16 a[0:15], v[100:103], a[72:75], a[0:15]
    v_mfma_f32_32x32x16_bf16 a[16:31], v[100:103], a[76:79], a[16:31]
    s_waitcnt vmcnt(16)
    v_cmp_ne_u32_e64 vcc, s8, v8
    s_cbranch_vccnz L_bretry_21
L_bback_22:
    s_add_u32 s12, s96, 64
    s_lshl_b32 s12, s12, 10
    s_add_u32 s12, s12, s84
    s_add_u32 s13, s12, 153600
    buffer_load_dwordx4 a[64:67], v4, s[64:67], s12 offen offset:0 sc1
    v_mfma_f32_32x32x16_bf16 a[32:47], v[116:119], a[72:75], a[32:47]
    v_mfma_f32_32x32x16_bf16 a[48:63], v[116:119], a[76:79], a[48:63]
    v_and_b32 v80, 7, v2
    v_xor_b32 v80, v80, v3
    v_lshlrev_b32_e64 v80, 4, v80
    v_lshl_add_u32 v80, v2, 8, v80
    v_add_u32 v80, s93, v80
    v_xor_b32 v81, 32, v80
    v_xor_b32 v82, 64, v80
    v_xor_b32 v83, 96, v80
    s_waitcnt vmcnt(15)
    v_mfma_f32_32x32x16_bf16 a[0:15], v[104:107], a[80:83], a[0:15]
    v_mfma_f32_32x32x16_bf16 a[16:31], v[104:107], a[84:87], a[16:31]
    buffer_load_dwordx4 a[72:75], v4, s[64:67], s12 offen offset:1024 sc1
    v_mfma_f32_32x32x16_bf16 a[32:47], v[120:123], a[80:83], a[32:47]
    v_mfma_f32_32x32x16_bf16 a[48:63], v[120:123], a[84:87], a[48:63]
    s_add_u32 s10, s93, 4096
    v_add_u32 v84, s10, v10
    v_add_u32 v85, s10, v11
    ds_read_b64_tr_b16 v[32:33], v84 offset:0
    ds_read_b64_tr_b16 v[34:35], v84 offset:1024
    ds_read_b64_tr_b16 v[36:37], v85 offset:0
    ds_read_b64_tr_b16 v[38:39], v85 offset:1024
    s_waitcnt vmcnt(14)
    v_mfma_f32_32x32x16_bf16 a[0:15], v[108:111], a[88:91], a[0:15]
    v_xor_b32 v12, 0, v1
    ds_read_b128 v[16:19], v12 offset:0
    ds_read_b128 v[20:23], v12 offset:16384
    v_mfma_f32_32x32x16_bf16 a[16:31], v[108:111], a[92:95], a[16:31]
    s_add_u32 s12, s96, 70
    s_lshl_b32 s12, s12, 10
    s_add_u32 s12, s12, s84
    s_add_u32 s13, s12, 153600
    buffer_load_dwordx4 a[80:83], v4, s[64:67], s12 offen offset:0 sc1
    v_mfma_f32_32x32x16_bf16 a[32:47], v[124:127], a[88:91], a[32:47]
    v_mfma_f32_32x32x16_bf16 a[48:63], v[124:127], a[92:95], a[48:63]
    ds_read_b64_tr_b16 v[40:41], v84 offset:2048
    ds_read_b64_tr_b16 v[42:43], v84 offset:3072
    ds_read_b64_tr_b16 v[44:45], v85 offset:2048
    ds_read_b64_tr_b16 v[46:47], v85 offset:3072
    s_waitcnt vmcnt(9) lgkmcnt(4)
    v_mfma_f32_32x32x16_bf16 a[0:15], v[16:19], a[96:99], a[0:15]
    v_xor_b32 v12, 32, v1
    ds_read_b128 v[24:27], v12 offset:0
    ds_read_b128 v[28:31], v12 offset:16384
    v_mfma_f32_32x32x16_bf16 a[16:31], v[16:19], a[100:103], a[16:31]
    buffer_load_dwordx4 a[88:91], v4, s[64:67], s12 offen offset:1024 sc1
    v_mfma_f32_32x32x16_bf16 a[32:47], v[20:23], a[96:99], a[32:47]
    v_mfma_f32_32x32x16_bf16 a[48:63], v[20:23], a[100:103], a[48:63]
    s_add_u32 s10, s34, 32768
    v_add_u32 v84, s10, v10
    v_add_u32 v85, s10, v11
    ds_read_b64_tr_b16 v[48:49], v84 offset:0
    ds_read_b64_tr_b16 v[50:51], v84 offset:1024
    ds_read_b64_tr_b16 v[52:53], v85 offset:0
    ds_read_b64_tr_b16 v[54:55], v85 offset:1024
    s_waitcnt vmcnt(8) lgkmcnt(4)
    v_mfma_f32_32x32x16_bf16 a[0:15], v[24:27], a[104:107], a[0:15]
    v_xor_b32 v12, 64, v1
    ds_read_b128 v[16:19], v12 offset:0
    ds_read_b128 v[20:23], v12 offset:16384
    v_mfma_f32_32x32x16_bf16 a[16:31], v[24:27], a[108:111], a[16:31]
    s_add_u32 s12, s7, 64
    s_lshl_b32 s12, s12, 10
    s_add_u32 s12, s12, s84
    s_add_u32 s13, s12, 153600
    buffer_load_dwordx4 a[96:99], v4, s[64:67], s12 offen offset:0 sc1
    v_mfma_f32_32x32x16_bf16 a[32:47], v[28:31], a[104:107], a[32:47]
    v_mfma_f32_32x32x16_bf16 a[48:63], v[28:31], a[108:111], a[48:63]
    ds_read_b64_tr_b16 v[56:57], v84 offset:2048
    ds_read_b64_tr_b16 v[58:59], v84 offset:3072
    ds_read_b64_tr_b16 v[60:61], v85 offset:2048
    ds_read_b64_tr_b16 v[62:63], v85 offset:3072
    s_waitcnt vmcnt(7) lgkmcnt(4)
    v_mfma_f32_32x32x16_bf16 a[0:15], v[16:19], a[112:115], a[0:15]
    v_xor_b32 v12, 96, v1
    ds_read_b128 v[24:27], v12 offset:0
    ds_read_b128 v[28:31], v12 offset:16384
    v_mfma_f32_32x32x16_bf16 a[16:31], v[16:19], a[116:119], a[16:31]
    buffer_load_dwordx4 a[104:107], v4, s[64:67], s12 offen offset:1024 sc1
    s_add_u32 s13, s96, 214
    s_lshl_b32 s13, s13, 10
    s_add_u32 s13, s13, s84
    buffer_load_dwordx4 a[68:71], v4, s[64:67], s13 offen offset:0 sc1
    v_mfma_f32_32x32x16_bf16 a[32:47], v[20:23], a[112:115], a[32:47]
    buffer_load_dwordx4 a[76:79], v4, s[64:67], s13 offen offset:1024 sc1
    s_add_u32 s13, s96, 220
    s_lshl_b32 s13, s13, 10
    s_add_u32 s13, s13, s84
    buffer_load_dwordx4 a[84:87], v4, s[64:67], s13 offen offset:0 sc1
    v_mfma_f32_32x32x16_bf16 a[48:63], v[20:23], a[116:119], a[48:63]
    s_add_u32 s10, s93, 32768
    v_add_u32 v84, s10, v10
    v_add_u32 v85, s10, v11
    ds_read_b64_tr_b16 v[64:65], v84 offset:0
    ds_read_b64_tr_b16 v[66:67], v84 offset:1024
    ds_read_b64_tr_b16 v[68:69], v85 offset:0
    ds_read_b64_tr_b16 v[70:71], v85 offset:1024
    s_waitcnt vmcnt(9) lgkmcnt(4)
    v_mfma_f32_32x32x16_bf16 a[0:15], v[24:27], a[120:123], a[0:15]
    v_mfma_f32_32x32x16_bf16 a[16:31], v[24:27], a[124:127], a[16:31]
    buffer_load_dwordx4 a[92:95], v4, s[64:67], s13 offen offset:1024 sc1
    s_add_u32 s13, s7, 214
    s_lshl_b32 s13, s13, 10
    s_add_u32 s13, s13, s84
    buffer_load_dwordx4 a[100:103], v4, s[64:67], s13 offen offset:0 sc1
    v_mfma_f32_32x32x16_bf16 a[32:47], v[28:31], a[120:123], a[32:47]
    buffer_load_dwordx4 a[108:111], v4, s[64:67], s13 offen offset:1024 sc1
    v_mfma_f32_32x32x16_bf16 a[48:63], v[28:31], a[124:127], a[48:63]
    ds_read_b64_tr_b16 v[72:73], v84 offset:2048
    ds_read_b64_tr_b16 v[74:75], v84 offset:3072
    ds_read_b64_tr_b16 v[76:77], v85 offset:2048
    ds_read_b64_tr_b16 v[78:79], v85 offset:3072
    s_waitcnt lgkmcnt(0)
    s_waitcnt vmcnt(11)
    v_mfma_f32_32x32x16_bf16 a[0:15], v[32:35], a[64:67], a[0:15]
    v_mfma_f32_32x32x16_bf16 a[32:47], v[36:39], a[64:67], a[32:47]
    s_waitcnt vmcnt(10)
    v_mfma_f32_32x32x16_bf16 a[0:15], v[40:43], a[72:75], a[0:15]
    v_mfma_f32_32x32x16_bf16 a[32:47], v[44:47], a[72:75], a[32:47]
    s_waitcnt vmcnt(9)
    v_mfma_f32_32x32x16_bf16 a[0:15], v[48:51], a[80:83], a[0:15]
    v_mfma_f32_32x32x16_bf16 a[32:47], v[52:55], a[80:83], a[32:47]
    s_waitcnt vmcnt(8)
    v_mfma_f32_32x32x16_bf16 a[0:15], v[56:59], a[88:91], a[0:15]
    v_mfma_f32_32x32x16_bf16 a[32:47], v[60:63], a[88:91], a[32:47]
    s_waitcnt vmcnt(7)
    s_cmp_eq_u32 s3, 3
    s_cbranch_scc1 L_bsk_23
    v_mfma_f32_32x32x16_bf16 a[0:15], v[64:67], a[96:99], a[0:15]
    v_mfma_f32_32x32x16_bf16 a[32:47], v[68:71], a[96:99], a[32:47]
    s_waitcnt vmcnt(6)
    v_mfma_f32_32x32x16_bf16 a[0:15], v[72:75], a[104:107], a[0:15]
    v_mfma_f32_32x32x16_bf16 a[32:47], v[76:79], a[104:107], a[32:47]
L_bsk_23:
    s_waitcnt vmcnt(5)
    v_mfma_f32_32x32x16_bf16 a[16:31], v[32:35], a[68:71], a[16:31]
    v_mfma_f32_32x32x16_bf16 a[48:63], v[36:39], a[68:71], a[48:63]
    s_waitcnt vmcnt(4)
    v_mfma_f32_32x32x16_bf16 a[16:31], v[40:43], a[76:79], a[16:31]
    s_nop 5
    ds_write_b128 v80, a[0:3] offset:0
    v_mfma_f32_32x32x16_bf16 a[48:63], v[44:47], a[76:79], a[48:63]
    ds_write_b128 v81, a[4:7] offset:0
    s_waitcnt vmcnt(3)
    v_mfma_f32_32x32x16_bf16 a[16:31], v[48:51], a[84:87], a[16:31]
    ds_write_b128 v82, a[8:11] offset:0
    ds_write_b128 v83, a[12:15] offset:0
    v_mfma_f32_32x32x16_bf16 a[48:63], v[52:55], a[84:87], a[48:63]
    ds_write_b128 v80, a[32:35] offset:128
    ds_write_b128 v81, a[36:39] offset:128
    s_waitcnt vmcnt(2)
    v_mfma_f32_32x32x16_bf16 a[16:31], v[56:59], a[92:95], a[16:31]
    ds_write_b128 v82, a[40:43] offset:128
    ds_write_b128 v83, a[44:47] offset:128
    v_mfma_f32_32x32x16_bf16 a[48:63], v[60:63], a[92:95], a[48:63]
    s_waitcnt vmcnt(1)
    s_cmp_eq_u32 s3, 3
    s_cbranch_scc1 L_bsk_24
    v_mfma_f32_32x32x16_bf16 a[16:31], v[64:67], a[100:103], a[16:31]
    v_mfma_f32_32x32x16_bf16 a[48:63], v[68:71], a[100:103], a[48:63]
    s_waitcnt vmcnt(0)
    v_mfma_f32_32x32x16_bf16 a[16:31], v[72:75], a[108:111], a[16:31]
    v_mfma_f32_32x32x16_bf16 a[48:63], v[76:79], a[108:111], a[48:63]
L_bsk_24:
    s_waitcnt lgkmcnt(0)
    s_barrier
    s_nop 8
    ds_write_b128 v80, a[16:19] offset:32768
    ds_write_b128 v81, a[20:23] offset:32768
    ds_write_b128 v82, a[24:27] offset:32768
    ds_write_b128 v83, a[28:31] offset:32768
    ds_write_b128 v80, a[48:51] offset:32896
    ds_write_b128 v81, a[52:55] offset:32896
    ds_write_b128 v82, a[56:59] offset:32896
    ds_write_b128 v83, a[60:63] offset:32896
    s_waitcnt lgkmcnt(0)
    s_barrier
L_end:
    s_endpgm
L_alw_3:
    s_sleep 1
    ds_read_b128 v[6:9], v0 offset:9520
    s_add_u32 s98, s98, 1
    s_waitcnt lgkmcnt(0)
    v_min3_u32 v6, v6, v7, v8
    v_min_u32 v6, v6, v9
    v_cmp_gt_u32 vcc, 1, v6
    s_cmp_gt_u32 s98, 8000000
    s_cbranch_scc1 L_alwb_4
    s_cbranch_vccnz L_alw_3
    s_branch L_alwb_4
L_alw_5:
    s_sleep 1
    ds_read_b128 v[10:13], v0 offset:9504
    s_add_u32 s98, s98, 1
    s_waitcnt lgkmcnt(0)
    v_min3_u32 v10, v10, v11, v12
    v_min_u32 v10, v10, v13
    v_cmp_gt_u32 vcc, 1, v10
    s_cmp_gt_u32 s98, 8000000
    s_cbranch_scc1 L_alwb_6
    s_cbranch_vccnz L_alw_5
    s_branch L_alwb_6
L_alw_8:
    s_sleep 1
    ds_read_b128 v[6:9], v0 offset:9472
    s_add_u32 s98, s98, 1
    s_waitcnt lgkmcnt(0)
    v_min3_u32 v6, v6, v7, v8
    v_min_u32 v6, v6, v9
    v_cmp_gt_u32 vcc, 6, v6
    s_cmp_gt_u32 s98, 8000000
    s_cbranch_scc1 L_alwb_9
    s_cbranch_vccnz L_alw_8
    s_branch L_alwb_9
L_alw_10:
    s_sleep 1
    ds_read_b128 v[6:9], v0 offset:9472
    s_add_u32 s98, s98, 1
    s_waitcnt lgkmcnt(0)
    v_min3_u32 v6, v6, v7, v8
    v_min_u32 v6, v6, v9
    v_cmp_gt_u32 vcc, 9, v6
    s_cmp_gt_u32 s98, 8000000
    s_cbranch_scc1 L_alwb_11
    s_cbranch_vccnz L_alw_10
    s_branch L_alwb_11
L_alw_12:
    s_sleep 1
    ds_read_b128 v[6:9], v0 offset:9472
    s_add_u32 s98, s98, 1
    s_waitcnt lgkmcnt(0)
    v_min3_u32 v6, v6, v7, v8
    v_min_u32 v6, v6, v9
    v_cmp_gt_u32 vcc, 12, v6
    s_cmp_gt_u32 s98, 8000000
    s_cbranch_scc1 L_alwb_13
    s_cbranch_vccnz L_alw_12
    s_branch L_alwb_13
L_aretry_14:
    s_sleep 1
    ds_read_b32 v12, v0 offset:9536
    ds_read_b64 v[10:11], v85 offset:9216
    s_waitcnt lgkmcnt(0)
    v_cmp_eq_u32 vcc, 0, v12
    s_add_u32 s98, s98, 1
    s_cmp_gt_u32 s98, 4000000
    s_cbranch_scc1 L_aback_15
    s_cbranch_vccnz L_aretry_14
    s_branch L_aback_15
L_bretry_1:
    s_sleep 2
    s_nop 3
    buffer_load_dwordx4 v[80:83], v100, s[64:67], s99 offen sc1
    buffer_load_dwordx4 v[84:87], v101, s[64:67], s100 offen offset:0 sc1
    buffer_load_dwordx4 v[88:91], v101, s[64:67], s100 offen offset:768 sc1
    buffer_load_dwordx4 v[92:95], v101, s[64:67], s100 offen offset:1536 sc1
    buffer_load_dwordx4 v[96:99], v101, s[64:67], s100 offen offset:2304 sc1
    s_waitcnt vmcnt(0)
    v_xor_b32 v32, s8, v81
    v_bitop3_b32 v32, v32, v83, s8 bitop3:0xf6
    v_bitop3_b32 v32, v32, v85, s9 bitop3:0xf6
    v_bitop3_b32 v32, v32, v87, s9 bitop3:0xf6
    v_bitop3_b32 v32, v32, v89, s9 bitop3:0xf6
    v_bitop3_b32 v32, v32, v91, s9 bitop3:0xf6
    v_bitop3_b32 v32, v32, v93, s9 bitop3:0xf6
    v_bitop3_b32 v32, v32, v95, s9 bitop3:0xf6
    v_bitop3_b32 v32, v32, v97, s9 bitop3:0xf6
    v_bitop3_b32 v32, v32, v99, s9 bitop3:0xf6
    v_cmp_ne_u32_e64 vcc, 0, v32
    s_add_u32 s98, s98, 1
    s_cmp_gt_u32 s98, 200000
    s_cbranch_scc1 L_bback_2
    s_cbranch_vccnz L_bretry_1
    s_branch L_bback_2
L_bretry_5:
    s_sleep 2
    buffer_load_dwordx4 a[0:3], v126, s[64:67], s101 offen offset:0 sc1
    buffer_load_dwordx4 a[4:7], v126, s[64:67], s101 offen offset:512 sc1
    buffer_load_dwordx4 a[8:11], v126, s[64:67], s101 offen offset:1024 sc1
    buffer_load_dwordx4 a[12:15], v126, s[64:67], s101 offen offset:1536 sc1
    buffer_load_dwordx4 a[16:19], v126, s[64:67], s101 offen offset:2048 sc1
    buffer_load_dwordx4 a[20:23], v126, s[64:67], s101 offen offset:2560 sc1
    buffer_load_dwordx4 a[24:27], v126, s[64:67], s101 offen offset:3072 sc1
    buffer_load_dwordx4 a[28:31], v126, s[64:67], s101 offen offset:3584 sc1
    s_waitcnt vmcnt(0)
    v_accvgpr_read_b32 v16, a1
    v_accvgpr_read_b32 v17, a3
    v_accvgpr_read_b32 v18, a5
    v_accvgpr_read_b32 v19, a7
    v_accvgpr_read_b32 v20, a9
    v_accvgpr_read_b32 v21, a11
    v_accvgpr_read_b32 v22, a13
    v_accvgpr_read_b32 v23, a15
    v_accvgpr_read_b32 v24, a17
    v_accvgpr_read_b32 v25, a19
    v_accvgpr_read_b32 v26, a21
    v_accvgpr_read_b32 v27, a23
    v_accvgpr_read_b32 v28, a25
    v_accvgpr_read_b32 v29, a27
    v_accvgpr_read_b32 v30, a29
    v_accvgpr_read_b32 v31, a31
    v_xor_b32_e64 v12, s9, v16
    v_bitop3_b32 v12, v12, v17, s9 bitop3:0xf6
    v_bitop3_b32 v12, v12, v18, s9 bitop3:0xf6
    v_bitop3_b32 v12, v12, v19, s9 bitop3:0xf6
    v_bitop3_b32 v12, v12, v20, s9 bitop3:0xf6
    v_bitop3_b32 v12, v12, v21, s9 bitop3:0xf6
    v_bitop3_b32 v12, v12, v22, s9 bitop3:0xf6
    v_bitop3_b32 v12, v12, v23, s9 bitop3:0xf6
    v_bitop3_b32 v12, v12, v24, s9 bitop3:0xf6
    v_bitop3_b32 v12, v12, v25, s9 bitop3:0xf6
    v_bitop3_b32 v12, v12, v26, s9 bitop3:0xf6
    v_bitop3_b32 v12, v12, v27, s9 bitop3:0xf6
    v_bitop3_b32 v12, v12, v28, s9 bitop3:0xf6
    v_bitop3_b32 v12, v12, v29, s9 bitop3:0xf6
    v_bitop3_b32 v12, v12, v30, s9 bitop3:0xf6
    v_bitop3_b32 v12, v12, v31, s9 bitop3:0xf6
    v_cmp_ne_u32 vcc, 0, v12
    s_add_u32 s98, s98, 1
    s_cmp_gt_u32 s98, 200000
    s_cbranch_scc1 L_bback_6
    s_cbranch_vccnz L_bretry_5
    s_branch L_bback_6
L_blw_8:
    s_sleep 1
    ds_read_b128 v[28:31], v0 offset:9488
    s_add_u32 s98, s98, 1
    s_waitcnt lgkmcnt(0)
    v_min3_u32 v28, v28, v29, v30
    v_min_u32 v28, v28, v31
    v_cmp_gt_u32 vcc, 9, v28
    s_cmp_gt_u32 s98, 8000000
    s_cbranch_scc1 L_blwb_9
    s_cbranch_vccnz L_blw_8
    s_branch L_blwb_9
L_blw_10:
    s_sleep 1
    ds_read_b128 v[28:31], v0 offset:9488
    s_add_u32 s98, s98, 1
    s_waitcnt lgkmcnt(0)
    v_min3_u32 v28, v28, v29, v30
    v_min_u32 v28, v28, v31
    v_cmp_gt_u32 vcc, 10, v28
    s_cmp_gt_u32 s98, 8000000
    s_cbranch_scc1 L_blwb_11
    s_cbranch_vccnz L_blw_10
    s_branch L_blwb_11
L_blw_12:
    s_sleep 1
    ds_read_b128 v[28:31], v0 offset:9488
    s_add_u32 s98, s98, 1
    s_waitcnt lgkmcnt(0)
    v_min3_u32 v28, v28, v29, v30
    v_min_u32 v28, v28, v31
    v_cmp_gt_u32 vcc, 11, v28
    s_cmp_gt_u32 s98, 8000000
    s_cbranch_scc1 L_blwb_13
    s_cbranch_vccnz L_blw_12
    s_branch L_blwb_13
L_bretry_14:
    s_sleep 2
    s_add_u32 s1, s85, 0
    buffer_load_dword v8, v15, s[64:67], s1 offen sc1
    s_waitcnt vmcnt(0)
    v_cmp_ne_u32 vcc, s8, v8
    s_add_u32 s98, s98, 1
    s_cmp_gt_u32 s98, 200000
    s_cbranch_scc1 L_bback_15
    s_cbranch_vccnz L_bretry_14
    s_branch L_bback_15
L_bretry_17:
    s_sleep 2
    s_add_u32 s1, s85, 8192
    buffer_load_dword v8, v15, s[64:67], s1 offen sc1
    s_waitcnt vmcnt(0)
    v_cmp_ne_u32_e64 vcc, s8, v8
    s_add_u32 s98, s98, 1
    s_cmp_gt_u32 s98, 200000
    s_cbranch_scc1 L_bback_18
    s_cbranch_vccnz L_bretry_17
    s_branch L_bback_18
L_bretry_19:
    s_sleep 2
    s_add_u32 s1, s85, 16384
    buffer_load_dword v8, v15, s[64:67], s1 offen sc1
    s_waitcnt vmcnt(0)
    v_cmp_ne_u32_e64 vcc, s8, v8
    s_add_u32 s98, s98, 1
    s_cmp_gt_u32 s98, 200000
    s_cbranch_scc1 L_bback_20
    s_cbranch_vccnz L_bretry_19
    s_branch L_bback_20
L_bretry_21:
    s_sleep 2
    s_add_u32 s1, s85, 24576
    buffer_load_dword v8, v9, s[64:67], s1 offen sc1
    s_waitcnt vmcnt(0)
    v_cmp_ne_u32 vcc, s8, v8
    s_add_u32 s98, s98, 1
    s_cmp_gt_u32 s98, 200000
    s_cbranch_scc1 L_bback_22
    s_cbranch_vccnz L_bretry_21
    s_branch L_bback_22
.section .rodata,"a"
.p2align 6
.amdhsa_kernel gated_mix__ssm_conv_s5__mixer_channel_mlp__prompt_kernel
  .amdhsa_next_free_vgpr 256
  .amdhsa_next_free_sgpr 102
  .amdhsa_accum_offset 128
  .amdhsa_group_segment_fixed_size 0
  .amdhsa_kernarg_size 144
  .amdhsa_user_sgpr_count 2
  .amdhsa_user_sgpr_kernarg_segment_ptr 1
  .amdhsa_system_sgpr_workgroup_id_x 1
  .amdhsa_float_denorm_mode_32 3
.end_amdhsa_kernel
```
